```python
import torch

def _softmax(x, axis=-1):
    return torch.softmax(x, dim=axis)
def _gelu(x):
    return torch.nn.functional.gelu(x, approximate="tanh")
def _silu(x):
    return torch.nn.functional.silu(x)
def _sigmoid(x):
    return torch.sigmoid(x)
def _layernorm(x, axis=-1, eps=1e-5):
    m = x.mean(dim=axis, keepdim=True)
    v = x.var(dim=axis, keepdim=True, unbiased=False)
    return (x - m) / torch.sqrt(v + eps)
def _scatter_add(tgt, idx, src, axis=0):
    return tgt.clone().index_add_(axis, idx, src)
def _segment_sum(src, seg, n):
    out = torch.zeros((n,) + src.shape[1:], dtype=src.dtype)
    return out.index_add_(0, seg, src)
def _pad(x, pw):
    flat = tuple(v for pair in reversed(pw) for v in pair)
    return torch.nn.functional.pad(x, flat)

kernel_name = 'gated_mix__spectral_gfnet__dense_activation_mish__prompt'

def setup_inputs():

    _w = (lambda a: (lambda t: t.to(torch.bfloat16) if t.is_floating_point() else t)(torch.as_tensor(a)))
    def _A_setup():
        B, S, D = 1, 2048, 448
        Df = D // 2 + 1
        return {
            "x": _w((lambda *s: torch.randn(*s, dtype=torch.bfloat16) * 0.05)(B, S, D)),
            "w_r": _w((lambda *s: torch.randn(*s, dtype=torch.bfloat16) * 1.6)(S, Df) * 0.02),
            "w_i": _w((lambda *s: torch.randn(*s, dtype=torch.bfloat16) * 1.6)(S, Df) * 0.02),
        }
    _A_in = _A_setup()

    def _B_setup():
        B, S, D, F = 1, 2048, 448, 1792
        return {
            "x": _w((lambda *s: torch.randn(*s, dtype=torch.bfloat16) * 0.05)(B, S, D)),
            "w1": _w((lambda *s: torch.randn(*s, dtype=torch.bfloat16) * 6.4)(D, F) * (D ** -0.5)),
            "b1": _w((lambda *s: torch.randn(*s, dtype=torch.bfloat16) * 0.05)(F)),
            "w2": _w((lambda *s: torch.randn(*s, dtype=torch.bfloat16) * 0.05)(F, D) * (F ** -0.5)),
        }
    _B_in = _B_setup()

    return {
        "A_x": _A_in["x"],
        "A_w_r": _A_in["w_r"],
        "A_w_i": _A_in["w_i"],
        "B_x": _B_in["x"],
        "B_w1": _B_in["w1"],
        "B_b1": _B_in["b1"],
        "B_w2": _B_in["w2"],
        "gate_w": _w((lambda *s: torch.randn(*s, dtype=torch.bfloat16) * 0.05)(448) * 16.0),
    }

def reference(A_x, A_w_r, A_w_i, B_x, B_w1, B_b1, B_w2, gate_w):
    def _A_ref(x, w_r, w_i):
        B, S, D = x.shape
        X = (lambda x, axes=(-2,-1): torch.fft.rfft2(x.float(), dim=axes))(x, axes=(-2, -1))
        W = w_r + 1j * w_i
        X = X * W
        y = (lambda x, s, axes=(-2,-1): torch.fft.irfft2(x, s=s, dim=axes).to(torch.bfloat16))(X, (S, D), axes=(-2, -1))
        return y

    def _B_ref(x, w1, b1, w2):
        h = torch.einsum("bsd,df->bsf", x, w1) + b1
        sp = torch.log1p(torch.exp(-torch.abs(h))) + torch.where(h > 0, h, torch.zeros_like(h))
        act = h * torch.tanh(sp)
        return torch.einsum("bsf,fd->bsd", act, w2)

    x = A_x
    g = _sigmoid((x * gate_w).sum(-1, keepdims=True))
    a = _A_ref(x, A_w_r, A_w_i)
    b = _B_ref(x, B_w1, B_b1, B_w2)
    return g * a + (1 - g) * b
```

```asm
; @launch grid=(256,1,1) block=(512,1,1) lds=163840
.amdgcn_target "amdgcn-amd-amdhsa--gfx950"
.text
.globl gated_mix__spectral_gfnet__dense_activation_mish__prompt_kernel
.p2align 8
.type gated_mix__spectral_gfnet__dense_activation_mish__prompt_kernel,@function
gated_mix__spectral_gfnet__dense_activation_mish__prompt_kernel:
    s_cmp_ge_u32 s2, 256
    s_cbranch_scc1 L_end
    s_load_dwordx16 s[4:19], s[0:1], 0
    s_load_dwordx2 s[26:27], s[0:1], 64
    s_load_dwordx2 s[24:25], s[0:1], 80
    s_cmp_lt_u32 s2, 224
    s_cbranch_scc1 L_nocp
    s_getpc_b64 s[56:57]
L_pc:
    s_mov_b32 s58, L_end-L_pc
    s_mov_b32 s59, 0x00020000
    s_sub_u32 s72, s2, 224
    s_lshr_b32 s72, s72, 3
    s_lshl_b32 s72, s72, 7
    v_lshlrev_b32 v6, 9, v0
    buffer_load_dword v23, v6, s[56:59], s72 offen
L_nocp:
    v_lshrrev_b32 v6, 6, v0
    v_and_b32 v1, 63, v0
    v_readfirstlane_b32 s64, v6
    v_and_b32 v2, 31, v0
    v_lshrrev_b32 v3, 5, v1
    v_and_b32 v4, 15, v0
    v_lshrrev_b32 v5, 4, v1
    v_lshlrev_b32 v7, 4, v1
    s_and_b32 s67, s2, 7
    s_lshr_b32 s72, s2, 3
    s_mul_i32 s65, s72, 37
    s_lshr_b32 s65, s65, 8
    s_mul_i32 s66, s65, 7
    s_sub_u32 s66, s72, s66
    s_lshr_b32 s68, s67, 1
    s_lshl_b32 s68, s68, 2
    s_add_u32 s68, s68, s65
    s_and_b32 s69, s67, 1
    s_mul_i32 s69, s69, 7
    s_add_u32 s69, s69, s66
    s_and_b32 s80, s64, 3
    s_lshr_b32 s81, s64, 2
    s_lshl_b32 s70, s68, 2
    s_add_u32 s70, s70, s80
    s_lshl_b32 s20, s80, 12
    s_lshl_b32 s21, s80, 11
    s_lshr_b32 s3, s80, 1
    v_lshrrev_b32 v32, 3, v1
    v_mul_u32_u24 v34, 896, v32
    v_lshrrev_b32 v33, 2, v1
    v_and_b32 v33, 4, v33
    v_xor_b32 v33, v33, v1
    v_and_b32 v33, 7, v33
    v_lshlrev_b32 v33, 4, v33
    v_add_u32 v11, v33, v34
    s_cmp_ge_u32 s65, 4
    s_cbranch_scc1 L_side
    s_cmp_eq_u32 s81, 0
    s_cbranch_scc1 L_x0
    v_lshl_add_u32 v10, v34, 2, v33
    v_and_b32 v33, 4, v32
    v_xor_b32 v33, v33, v1
    v_and_b32 v33, 7, v33
    v_lshl_add_u32 v176, v33, 4, v34
    v_xor_b32 v177, 16, v176
    v_add_u32 v177, 28672, v177
    v_xor_b32 v178, 32, v176
    v_add_u32 v178, 57344, v178
    v_xor_b32 v179, 48, v176
    v_add_u32 v179, 86016, v179
    s_and_b32 s72, s70, 1
    s_lshl_b32 s75, s72, 3
    s_and_b32 s72, s70, 8
    s_lshl_b32 s72, s72, 1
    s_add_u32 s75, s75, s72
    s_and_b32 s72, s70, 6
    s_lshl_b32 s72, s72, 6
    s_add_u32 s75, s75, s72
    s_and_b32 s72, s70, 48
    s_lshl_b32 s72, s72, 5
    s_add_u32 s75, s75, s72
    s_mul_i32 s75, s75, 896
    s_lshl_b32 s76, s69, 8
    s_mul_i32 s72, s80, 57344
    s_add_u32 s76, s76, s72
    s_add_u32 s22, s76, 128
    s_mov_b32 s30, 1835008
    s_mov_b32 s31, 0x00020000
    s_mov_b32 s34, 1605632
    s_mov_b32 s35, 0x00020000
    s_waitcnt lgkmcnt(0)
    s_mov_b64 s[28:29], s[4:5]
    s_mov_b64 s[32:33], s[12:13]
    s_add_u32 m0, s20, 32768
    s_nop 0
    buffer_load_dwordx4 v176, s[28:31], s75 offen lds
    s_add_u32 m0, s20, 33792
    s_nop 0
    buffer_load_dwordx4 v177, s[28:31], s75 offen lds
    s_add_u32 m0, s20, 34816
    s_nop 0
    buffer_load_dwordx4 v178, s[28:31], s75 offen lds
    s_add_u32 m0, s20, 35840
    s_nop 0
    buffer_load_dwordx4 v179, s[28:31], s75 offen lds
    s_add_u32 s75, s75, 128
    s_add_u32 m0, s20, 49152
    s_nop 0
    buffer_load_dwordx4 v176, s[28:31], s75 offen lds
    s_add_u32 m0, s20, 50176
    s_nop 0
    buffer_load_dwordx4 v177, s[28:31], s75 offen lds
    s_add_u32 m0, s20, 51200
    s_nop 0
    buffer_load_dwordx4 v178, s[28:31], s75 offen lds
    s_add_u32 m0, s20, 52224
    s_nop 0
    buffer_load_dwordx4 v179, s[28:31], s75 offen lds
    s_add_u32 s75, s75, 128
    s_add_u32 m0, s20, 65536
    s_nop 0
    buffer_load_dwordx4 v176, s[28:31], s75 offen lds
    s_add_u32 m0, s20, 66560
    s_nop 0
    buffer_load_dwordx4 v177, s[28:31], s75 offen lds
    s_add_u32 m0, s20, 67584
    s_nop 0
    buffer_load_dwordx4 v178, s[28:31], s75 offen lds
    s_add_u32 m0, s20, 68608
    s_nop 0
    buffer_load_dwordx4 v179, s[28:31], s75 offen lds
    s_add_u32 s75, s75, 128
    s_branch L_y1
L_x0:
    v_bfe_u32 v32, v1, 2, 2
    v_lshlrev_b32 v33, 7, v32
    v_and_b32 v34, 2, v32
    v_lshl_add_u32 v33, v34, 5, v33
    v_and_b32 v34, 16, v1
    v_lshl_add_u32 v33, v34, 1, v33
    v_and_b32 v32, 3, v1
    v_lshl_add_u32 v33, v32, 3, v33
    v_lshl_add_u32 v16, v3, 10, v33
    s_mul_i32 s72, s81, 57344
    s_add_u32 s72, s72, 16384
    v_add_u32 v16, s72, v16
    v_xor_b32 v17, 64, v16
    v_lshl_add_u32 v18, v3, 9, v33
    s_lshl_b32 s72, s3, 6
    v_xor_b32 v18, s72, v18
    s_mul_i32 s72, s3, 28672
    v_add_u32 v18, s72, v18
    v_xor_b32 v19, 64, v18
    v_bfe_u32 v33, v1, 2, 3
    v_and_b32 v34, 4, v33
    v_xor_b32 v34, v34, v32
    v_xor_b32 v34, v34, v3
    v_lshlrev_b32 v34, 4, v34
    v_lshl_add_u32 v34, v33, 7, v34
    v_lshl_add_u32 v34, v32, 10, v34
    v_add_u32 v12, s20, v34
    v_xor_b32 v13, 32, v12
    v_xor_b32 v14, 64, v12
    v_xor_b32 v15, 96, v12
    v_mov_b32 v36, 0
    v_lshlrev_b32 v35, 2, v1
    v_add_u32 v35, 159744, v35
    ds_write_b32 v35, v36
    s_lshl_b32 s72, s69, 4
    v_add_u32 v32, s72, v4
    v_and_b32 v33, 16, v1
    v_lshl_add_u32 v34, v32, 5, v33
    v_cmp_eq_u32 s[90:91], 16, v34
    v_cvt_f32_u32 v32, v32
    v_mul_f32 v32, 0x3b124925, v32
    v_cvt_f32_u32 v33, v33
    v_mul_f32 v33, 0x3c800000, v33
    v_cndmask_b32 v32, v32, 0.5, s[90:91]
    v_cndmask_b32 v33, v33, 0, s[90:91]
    s_lshl_b32 s72, s64, 4
    v_lshl_add_u32 v34, v3, 3, s72
    v_cvt_f32_u32 v34, v34
    v_fma_f32 v33, v34, v32, v33
    v_cos_f32 v60, v32
    v_add_u32 v22, 131072, v7
    s_lshl_b32 s72, s64, 10
    v_add_u32 v35, s72, v22
    v_add_f32 v60, v60, v60
    v_fmamk_f32 v39, v32, 0x40400000, v33
    v_fmamk_f32 v40, v32, 0x40800000, v33
    v_cos_f32 v39, v39
    v_cos_f32 v40, v40
    s_nop 0
    v_fma_f32 v41, v60, v40, -v39
    v_fma_f32 v38, v60, v39, -v40
    v_fma_f32 v42, v60, v41, -v40
    v_fma_f32 v37, v60, v38, -v39
    v_fma_f32 v43, v60, v42, -v41
    v_fma_f32 v36, v60, v37, -v38
    v_cvt_pk_bf16_f32 v120, v36, v37
    v_cvt_pk_bf16_f32 v121, v38, v39
    v_cvt_pk_bf16_f32 v122, v40, v41
    v_cvt_pk_bf16_f32 v123, v42, v43
    ds_write_b128 v35, v[120:123] offset:0
    v_fmamk_f32 v39, v32, 0x42860000, v33
    v_fmamk_f32 v40, v32, 0x42880000, v33
    v_cos_f32 v39, v39
    v_cos_f32 v40, v40
    s_nop 0
    v_fma_f32 v41, v60, v40, -v39
    v_fma_f32 v38, v60, v39, -v40
    v_fma_f32 v42, v60, v41, -v40
    v_fma_f32 v37, v60, v38, -v39
    v_fma_f32 v43, v60, v42, -v41
    v_fma_f32 v36, v60, v37, -v38
    v_cvt_pk_bf16_f32 v44, v36, v37
    v_cvt_pk_bf16_f32 v45, v38, v39
    v_cvt_pk_bf16_f32 v46, v40, v41
    v_cvt_pk_bf16_f32 v47, v42, v43
    ds_write_b128 v35, v[44:47] offset:4096
    v_fmamk_f32 v39, v32, 0x43030000, v33
    v_fmamk_f32 v40, v32, 0x43040000, v33
    v_cos_f32 v39, v39
    v_cos_f32 v40, v40
    s_nop 0
    v_fma_f32 v41, v60, v40, -v39
    v_fma_f32 v38, v60, v39, -v40
    v_fma_f32 v42, v60, v41, -v40
    v_fma_f32 v37, v60, v38, -v39
    v_fma_f32 v43, v60, v42, -v41
    v_fma_f32 v36, v60, v37, -v38
    v_cvt_pk_bf16_f32 v120, v36, v37
    v_cvt_pk_bf16_f32 v121, v38, v39
    v_cvt_pk_bf16_f32 v122, v40, v41
    v_cvt_pk_bf16_f32 v123, v42, v43
    ds_write_b128 v35, v[120:123] offset:8192
    v_fmamk_f32 v39, v32, 0x43430000, v33
    v_fmamk_f32 v40, v32, 0x43440000, v33
    v_cos_f32 v39, v39
    v_cos_f32 v40, v40
    s_nop 0
    v_fma_f32 v41, v60, v40, -v39
    v_fma_f32 v38, v60, v39, -v40
    v_fma_f32 v42, v60, v41, -v40
    v_fma_f32 v37, v60, v38, -v39
    v_fma_f32 v43, v60, v42, -v41
    v_fma_f32 v36, v60, v37, -v38
    v_cvt_pk_bf16_f32 v44, v36, v37
    v_cvt_pk_bf16_f32 v45, v38, v39
    v_cvt_pk_bf16_f32 v46, v40, v41
    v_cvt_pk_bf16_f32 v47, v42, v43
    ds_write_b128 v35, v[44:47] offset:12288
    s_waitcnt lgkmcnt(0)
    s_mov_b32 s36, s14
    s_mov_b32 s37, s15
    s_mov_b32 s38, 3584
    s_mov_b32 s39, 0x00020000
    v_lshlrev_b32 v6, 1, v1
    s_lshl_b32 s72, s69, 8
    s_lshl_b32 s73, s81, 7
    s_add_u32 s72, s72, s73
    buffer_load_ushort v48, v6, s[36:39], s72 offen
    s_mov_b32 s48, s24
    s_mov_b32 s49, s25
    s_mov_b32 s50, 20971520
    s_mov_b32 s51, 0x00020000
    s_mov_b64 exec, 1
    buffer_load_dword v23, v7, s[48:51], 0 offen
    s_mov_b64 exec, -1
    s_mov_b32 s40, s16
    s_mov_b32 s41, s17
    s_mov_b32 s42, 1605632
    s_mov_b32 s43, 0x00020000
    s_mov_b32 s44, s26
    s_mov_b32 s45, s27
    s_mov_b32 s46, 1835008
    s_mov_b32 s47, 0x00020000
    s_add_u32 s52, s24, 6291456
    s_addc_u32 s53, s25, 0
    s_mov_b32 s54, 1843200
    s_mov_b32 s55, 0x00020000
    v_mov_b32 v49, 0
    v_mov_b32 v53, 0
    v_mov_b32 v57, 0
    v_mov_b32 v50, 0
    v_mov_b32 v54, 0
    v_mov_b32 v58, 0
    v_mov_b32 v51, 0
    v_mov_b32 v55, 0
    v_mov_b32 v59, 0
    v_mul_u32_u24 v56, 0x3f80, v3
    v_sub_u32 v52, 0x3f80, v56
    s_mov_b32 s88, 0xbfb8aa3b
    s_mov_b32 s89, 0xbfb8aa3b
    s_mul_i32 s84, s70, 57
    s_mul_i32 s73, s81, 3648
    s_add_u32 s84, s84, s73
    s_lshl_b32 s73, s69, 2
    s_add_u32 s84, s84, s73
    s_lshl_b32 s84, s84, 10
    s_add_u32 s84, s84, 8388608
    s_lshl_b32 s77, s70, 1
    s_add_u32 s77, s77, s81
    s_lshl_b32 s77, s77, 4
    s_add_u32 s77, s77, s69
    s_lshl_b32 s77, s77, 2
    s_lshr_b32 s73, s77, 6
    s_mul_i32 s73, s73, 64
    s_add_u32 s77, s77, s73
    s_add_u32 s77, s77, 16384
    s_and_b32 s23, s67, 1
    s_mul_i32 s73, s23, 896
    s_lshl_b32 s74, s80, 4
    s_add_u32 s73, s73, s74
    s_mul_i32 s82, s73, 896
    s_lshl_b32 s73, s66, 7
    s_add_u32 s82, s82, s73
    s_lshl_b32 s86, s68, 1
    s_add_u32 s86, s86, s23
    s_xor_b32 s73, s81, 1
    s_lshl_b32 s90, s73, 1
    s_add_u32 s90, s90, s3
    s_xor_b32 s73, s86, s81
    s_lshl_b32 s91, s73, 1
    s_and_b32 s73, s80, 1
    s_add_u32 s91, s91, s73
    s_mul_i32 s83, s73, 14336
    s_mul_i32 s73, s3, 98304
    s_sub_u32 s73, 131072, s73
    s_add_u32 s83, s83, s73
    v_mul_u32_u24 v24, 144, v4
    s_mul_i32 s74, s64, 2304
    s_add_u32 s74, s74, 139264
    v_add_u32 v24, s74, v24
    v_lshl_add_u32 v24, v3, 4, v24
    v_and_b32 v25, 16, v1
    v_lshl_add_u32 v24, v25, 1, v24
    v_lshrrev_b32 v124, 3, v1
    v_and_b32 v125, 7, v1
    v_lshlrev_b32 v125, 4, v125
    v_mul_u32_u24 v25, 144, v124
    v_add3_u32 v25, v25, v125, s74
    v_mul_u32_u24 v6, 8192, v124
    v_add_u32 v6, v6, v125
    s_mov_b32 s78, s2
    s_cmp_eq_u32 s78, 224
    s_cselect_b32 s20, 0, s78
    s_lshr_b32 s20, s20, 4
    s_lshl_b32 s20, s20, 2
    s_add_u32 s20, s20, s64
    s_mul_i32 s20, s20, 128
    s_add_u32 s20, s20, 4096
    v_lshlrev_b32 v8, 4, v2
    v_lshrrev_b32 v9, 7, v8
    v_mul_u32_u24 v9, 0, v9
    v_add_u32 v8, v8, v9
    v_add_u32 v8, 12288, v8
    s_mul_i32 s75, s69, 131072
    s_lshl_b32 s73, s70, 7
    s_add_u32 s75, s75, s73
    s_add_u32 s75, s75, 2097152
    s_add_u32 s76, s75, 65536
    s_lshl_b32 s22, s69, 2
    s_lshr_b32 s73, s70, 4
    s_add_u32 s22, s22, s73
    s_mul_i32 s22, s22, 32
    s_and_b32 s73, s70, 15
    s_add_u32 s22, s22, s73
    s_lshl_b32 s22, s22, 2
    s_add_u32 s22, s22, 4096
    s_waitcnt lgkmcnt(0)
    s_barrier
    ds_read_b128 v[176:179], v22 offset:0
    ds_read_b128 v[180:183], v22 offset:1024
    ds_read_b128 v[184:187], v22 offset:2048
    ds_read_b128 v[188:191], v22 offset:3072
    ds_read_b128 a[0:3], v12 offset:32768
    ds_read_b128 a[4:7], v13 offset:32768
    ds_read_b128 a[8:11], v14 offset:32768
    ds_read_b128 a[12:15], v15 offset:32768
    s_waitcnt lgkmcnt(3)
    v_mfma_f32_32x32x16_bf16 v[96:111], a[0:3], v[176:179], 0
    s_waitcnt lgkmcnt(2)
    v_mfma_f32_32x32x16_bf16 v[96:111], a[4:7], v[180:183], v[96:111]
    s_waitcnt lgkmcnt(1)
    v_mfma_f32_32x32x16_bf16 v[96:111], a[8:11], v[184:187], v[96:111]
    s_waitcnt lgkmcnt(0)
    v_mfma_f32_32x32x16_bf16 v[96:111], a[12:15], v[188:191], v[96:111]
    v_fmamk_f32 v39, v32, 0x43818000, v33
    v_fmamk_f32 v40, v32, 0x43820000, v33
    v_cos_f32 v39, v39
    v_cos_f32 v40, v40
    s_nop 0
    v_fma_f32 v41, v60, v40, -v39
    v_fma_f32 v38, v60, v39, -v40
    v_fma_f32 v42, v60, v41, -v40
    v_fma_f32 v37, v60, v38, -v39
    v_fma_f32 v43, v60, v42, -v41
    v_fma_f32 v36, v60, v37, -v38
    v_cvt_pk_bf16_f32 v120, v36, v37
    v_cvt_pk_bf16_f32 v121, v38, v39
    v_cvt_pk_bf16_f32 v122, v40, v41
    v_cvt_pk_bf16_f32 v123, v42, v43
    ds_write_b128 v35, v[120:123] offset:16384
    ds_read_b128 v[176:179], v22 offset:4096
    ds_read_b128 v[180:183], v22 offset:5120
    ds_read_b128 v[184:187], v22 offset:6144
    ds_read_b128 v[188:191], v22 offset:7168
    s_waitcnt lgkmcnt(4)
    s_barrier
    ds_read_b128 a[16:19], v12 offset:49152
    ds_read_b128 a[20:23], v13 offset:49152
    ds_read_b128 a[24:27], v14 offset:49152
    ds_read_b128 a[28:31], v15 offset:49152
    s_waitcnt lgkmcnt(3)
    v_mfma_f32_32x32x16_bf16 v[96:111], a[16:19], v[176:179], v[96:111]
    s_waitcnt lgkmcnt(2)
    v_mfma_f32_32x32x16_bf16 v[96:111], a[20:23], v[180:183], v[96:111]
    s_waitcnt lgkmcnt(1)
    v_mfma_f32_32x32x16_bf16 v[96:111], a[24:27], v[184:187], v[96:111]
    s_waitcnt lgkmcnt(0)
    v_mfma_f32_32x32x16_bf16 v[96:111], a[28:31], v[188:191], v[96:111]
    v_fmamk_f32 v39, v32, 0x43a18000, v33
    v_fmamk_f32 v40, v32, 0x43a20000, v33
    v_cos_f32 v39, v39
    v_cos_f32 v40, v40
    s_nop 0
    v_fma_f32 v41, v60, v40, -v39
    v_fma_f32 v38, v60, v39, -v40
    v_fma_f32 v42, v60, v41, -v40
    v_fma_f32 v37, v60, v38, -v39
    v_fma_f32 v43, v60, v42, -v41
    v_fma_f32 v36, v60, v37, -v38
    v_cvt_pk_bf16_f32 v44, v36, v37
    v_cvt_pk_bf16_f32 v45, v38, v39
    v_cvt_pk_bf16_f32 v46, v40, v41
    v_cvt_pk_bf16_f32 v47, v42, v43
    ds_write_b128 v35, v[44:47] offset:20480
    ds_read_b128 v[176:179], v22 offset:8192
    ds_read_b128 v[180:183], v22 offset:9216
    ds_read_b128 v[184:187], v22 offset:10240
    ds_read_b128 v[188:191], v22 offset:11264
    s_waitcnt lgkmcnt(4)
    s_barrier
    v_add_u32 v12, 0x10000, v12
    v_add_u32 v13, 0x10000, v13
    v_add_u32 v14, 0x10000, v14
    v_add_u32 v15, 0x10000, v15
    ds_read_b128 a[32:35], v12 offset:0
    ds_read_b128 a[36:39], v13 offset:0
    ds_read_b128 a[40:43], v14 offset:0
    ds_read_b128 a[44:47], v15 offset:0
    s_waitcnt lgkmcnt(3)
    v_mfma_f32_32x32x16_bf16 v[96:111], a[32:35], v[176:179], v[96:111]
    s_waitcnt lgkmcnt(2)
    v_mfma_f32_32x32x16_bf16 v[96:111], a[36:39], v[180:183], v[96:111]
    s_waitcnt lgkmcnt(1)
    v_mfma_f32_32x32x16_bf16 v[96:111], a[40:43], v[184:187], v[96:111]
    s_waitcnt lgkmcnt(0)
    v_mfma_f32_32x32x16_bf16 v[96:111], a[44:47], v[188:191], v[96:111]
    v_fmamk_f32 v39, v32, 0x43c18000, v33
    v_fmamk_f32 v40, v32, 0x43c20000, v33
    v_cos_f32 v39, v39
    v_cos_f32 v40, v40
    s_nop 0
    v_fma_f32 v41, v60, v40, -v39
    v_fma_f32 v38, v60, v39, -v40
    v_fma_f32 v42, v60, v41, -v40
    v_fma_f32 v37, v60, v38, -v39
    v_fma_f32 v43, v60, v42, -v41
    v_fma_f32 v36, v60, v37, -v38
    v_cvt_pk_bf16_f32 v120, v36, v37
    v_cvt_pk_bf16_f32 v121, v38, v39
    v_cvt_pk_bf16_f32 v122, v40, v41
    v_cvt_pk_bf16_f32 v123, v42, v43
    ds_write_b128 v35, v[120:123] offset:24576
    ds_read_b128 v[176:179], v22 offset:12288
    ds_read_b128 v[180:183], v22 offset:13312
    ds_read_b128 v[184:187], v22 offset:14336
    ds_read_b128 v[188:191], v22 offset:15360
    s_waitcnt lgkmcnt(4)
    s_barrier
    ds_read_b128 a[48:51], v12 offset:16384
    ds_read_b128 a[52:55], v13 offset:16384
    ds_read_b128 a[56:59], v14 offset:16384
    ds_read_b128 a[60:63], v15 offset:16384
    s_waitcnt lgkmcnt(3)
    v_mfma_f32_32x32x16_bf16 v[96:111], a[48:51], v[176:179], v[96:111]
    s_waitcnt lgkmcnt(2)
    v_mfma_f32_32x32x16_bf16 v[96:111], a[52:55], v[180:183], v[96:111]
    s_waitcnt lgkmcnt(1)
    v_mfma_f32_32x32x16_bf16 v[96:111], a[56:59], v[184:187], v[96:111]
    s_waitcnt lgkmcnt(0)
    v_mfma_f32_32x32x16_bf16 v[96:111], a[60:63], v[188:191], v[96:111]
    ds_read_b128 v[176:179], v22 offset:16384
    ds_read_b128 v[180:183], v22 offset:17408
    ds_read_b128 v[184:187], v22 offset:18432
    ds_read_b128 v[188:191], v22 offset:19456
    s_waitcnt lgkmcnt(12)
    s_barrier
    ds_read_b128 v[128:131], v12 offset:32768
    ds_read_b128 v[132:135], v13 offset:32768
    ds_read_b128 v[136:139], v14 offset:32768
    ds_read_b128 v[140:143], v15 offset:32768
    s_waitcnt lgkmcnt(3)
    v_mfma_f32_32x32x16_bf16 v[96:111], v[128:131], v[176:179], v[96:111]
    s_waitcnt lgkmcnt(2)
    v_mfma_f32_32x32x16_bf16 v[96:111], v[132:135], v[180:183], v[96:111]
    s_waitcnt lgkmcnt(1)
    v_mfma_f32_32x32x16_bf16 v[96:111], v[136:139], v[184:187], v[96:111]
    s_waitcnt lgkmcnt(0)
    v_mfma_f32_32x32x16_bf16 v[96:111], v[140:143], v[188:191], v[96:111]
    ds_read_b128 v[176:179], v22 offset:20480
    ds_read_b128 v[180:183], v22 offset:21504
    ds_read_b128 v[184:187], v22 offset:22528
    ds_read_b128 v[188:191], v22 offset:23552
    s_waitcnt lgkmcnt(15)
    s_barrier
    ds_read_b128 v[144:147], v12 offset:49152
    ds_read_b128 v[148:151], v13 offset:49152
    ds_read_b128 v[152:155], v14 offset:49152
    ds_read_b128 v[156:159], v15 offset:49152
    s_waitcnt lgkmcnt(3)
    v_mfma_f32_32x32x16_bf16 v[96:111], v[144:147], v[176:179], v[96:111]
    s_waitcnt lgkmcnt(2)
    v_mfma_f32_32x32x16_bf16 v[96:111], v[148:151], v[180:183], v[96:111]
    s_waitcnt lgkmcnt(1)
    v_mfma_f32_32x32x16_bf16 v[96:111], v[152:155], v[184:187], v[96:111]
    s_waitcnt lgkmcnt(0)
    v_mfma_f32_32x32x16_bf16 v[96:111], v[156:159], v[188:191], v[96:111]
    ds_read_b128 v[176:179], v22 offset:24576
    ds_read_b128 v[180:183], v22 offset:25600
    ds_read_b128 v[184:187], v22 offset:26624
    ds_read_b128 v[188:191], v22 offset:27648
    s_waitcnt vmcnt(0)
    v_readfirstlane_b32 s71, v23
    s_nop 0
    s_mul_i32 s71, s71, 1664525
    s_add_u32 s71, s71, 1013904223
    s_mov_b32 s92, s71
    s_mov_b32 s93, s71
    v_mfma_f32_32x32x16_bf16 v[64:79], v[48:51], v[52:55], 0
    v_mfma_f32_32x32x16_bf16 v[80:95], v[48:51], v[56:59], 0
    s_waitcnt lgkmcnt(15)
    s_barrier
    v_subrev_u32 v12, 0x10000, v12
    v_subrev_u32 v13, 0x10000, v13
    v_subrev_u32 v14, 0x10000, v14
    v_subrev_u32 v15, 0x10000, v15
    ds_read_b128 v[160:163], v12 offset:0
    ds_read_b128 v[164:167], v13 offset:0
    ds_read_b128 v[168:171], v14 offset:0
    ds_read_b128 v[172:175], v15 offset:0
    s_waitcnt lgkmcnt(3)
    v_mfma_f32_32x32x16_bf16 v[96:111], v[160:163], v[176:179], v[96:111]
    s_waitcnt lgkmcnt(2)
    v_mfma_f32_32x32x16_bf16 v[96:111], v[164:167], v[180:183], v[96:111]
    s_waitcnt lgkmcnt(1)
    v_mfma_f32_32x32x16_bf16 v[96:111], v[168:171], v[184:187], v[96:111]
    s_waitcnt lgkmcnt(0)
    v_mfma_f32_32x32x16_bf16 v[96:111], v[172:175], v[188:191], v[96:111]
    s_nop 11
    v_cvt_pk_bf16_f32 v32, v96, v97
    v_cvt_pk_bf16_f32 v33, v98, v99
    v_cvt_pk_bf16_f32 v34, v100, v101
    v_cvt_pk_bf16_f32 v35, v102, v103
    v_cvt_pk_bf16_f32 v36, v104, v105
    v_cvt_pk_bf16_f32 v37, v106, v107
    v_cvt_pk_bf16_f32 v38, v108, v109
    v_cvt_pk_bf16_f32 v39, v110, v111
    v_permlane16_swap_b32 v32, v34
    v_permlane16_swap_b32 v33, v35
    ds_write_b128 v24, v[32:35] offset:0
    v_permlane16_swap_b32 v36, v38
    v_permlane16_swap_b32 v37, v39
    ds_write_b128 v24, v[36:39] offset:64
    ds_read_b128 v[120:123], v25 offset:0
    ds_read_b128 v[124:127], v25 offset:1152
    s_barrier
    ds_read_b64_tr_b16 v[96:97], v16 offset:0
    ds_read_b64_tr_b16 v[98:99], v16 offset:512
    ds_read_b64_tr_b16 v[100:101], v17 offset:0
    ds_read_b64_tr_b16 v[102:103], v17 offset:512
    ds_read_b64_tr_b16 v[104:105], v16 offset:2048
    ds_read_b64_tr_b16 v[106:107], v16 offset:2560
    ds_read_b64_tr_b16 v[108:109], v17 offset:2048
    ds_read_b64_tr_b16 v[110:111], v17 offset:2560
    s_waitcnt lgkmcnt(8)
    buffer_store_dwordx4 v[120:123], v6, s[48:51], s75 offen sc1
    buffer_store_dwordx4 v[124:127], v6, s[48:51], s76 offen sc1
    s_waitcnt lgkmcnt(6)
    v_mfma_f32_32x32x16_bf16 v[64:79], v[96:99], a[0:3], v[64:79]
    ds_read_b64_tr_b16 v[112:113], v16 offset:4096
    ds_read_b64_tr_b16 v[114:115], v16 offset:4608
    s_waitcnt lgkmcnt(6)
    v_mfma_f32_32x32x16_bf16 v[80:95], v[100:103], a[0:3], v[80:95]
    ds_read_b64_tr_b16 v[116:117], v17 offset:4096
    ds_read_b64_tr_b16 v[118:119], v17 offset:4608
    s_waitcnt lgkmcnt(6)
    v_mfma_f32_32x32x16_bf16 v[64:79], v[104:107], a[4:7], v[64:79]
    ds_read_b64_tr_b16 v[96:97], v16 offset:6144
    ds_read_b64_tr_b16 v[98:99], v16 offset:6656
    s_waitcnt lgkmcnt(6)
    v_mfma_f32_32x32x16_bf16 v[80:95], v[108:111], a[4:7], v[80:95]
    ds_read_b64_tr_b16 v[100:101], v17 offset:6144
    ds_read_b64_tr_b16 v[102:103], v17 offset:6656
    s_waitcnt lgkmcnt(6)
    v_mfma_f32_32x32x16_bf16 v[64:79], v[112:115], a[8:11], v[64:79]
    ds_read_b64_tr_b16 v[104:105], v16 offset:8192
    ds_read_b64_tr_b16 v[106:107], v16 offset:8704
    v_lshlrev_b32 v34, 2, v5
    v_cvt_f32_u32 v34, v34
    s_waitcnt lgkmcnt(6)
    v_mfma_f32_32x32x16_bf16 v[80:95], v[116:119], a[8:11], v[80:95]
    ds_read_b64_tr_b16 v[108:109], v17 offset:8192
    ds_read_b64_tr_b16 v[110:111], v17 offset:8704
    v_cvt_f32_u32 v35, v4
    s_lshl_b32 s72, s64, 4
    v_cvt_f32_u32 v38, s72
    s_waitcnt lgkmcnt(6)
    v_mfma_f32_32x32x16_bf16 v[64:79], v[96:99], a[12:15], v[64:79]
    ds_read_b64_tr_b16 v[112:113], v16 offset:10240
    ds_read_b64_tr_b16 v[114:115], v16 offset:10752
    v_add_f32 v36, v38, v34
    v_add_f32 v32, 0x00000000, v35
    s_waitcnt lgkmcnt(6)
    v_mfma_f32_32x32x16_bf16 v[80:95], v[100:103], a[12:15], v[80:95]
    ds_read_b64_tr_b16 v[116:117], v17 offset:10240
    ds_read_b64_tr_b16 v[118:119], v17 offset:10752
    v_mul_f32 v32, 0x3a000000, v32
    v_mul_f32 v33, v32, v36
    s_waitcnt lgkmcnt(6)
    v_mfma_f32_32x32x16_bf16 v[64:79], v[104:107], a[16:19], v[64:79]
    ds_read_b64_tr_b16 v[96:97], v16 offset:12288
    ds_read_b64_tr_b16 v[98:99], v16 offset:12800
    v_mov_b32 v184, v33
    v_add_f32 v185, v32, v33
    s_waitcnt lgkmcnt(6)
    v_mfma_f32_32x32x16_bf16 v[80:95], v[108:111], a[16:19], v[80:95]
    ds_read_b64_tr_b16 v[100:101], v17 offset:12288
    ds_read_b64_tr_b16 v[102:103], v17 offset:12800
    v_fmamk_f32 v186, v32, 0x40000000, v33
    v_fmamk_f32 v187, v32, 0x40400000, v33
    s_waitcnt lgkmcnt(6)
    v_mfma_f32_32x32x16_bf16 v[64:79], v[112:115], a[20:23], v[64:79]
    ds_read_b64_tr_b16 v[104:105], v16 offset:14336
    ds_read_b64_tr_b16 v[106:107], v16 offset:14848
    v_add_f32 v32, 0x41800000, v35
    v_mul_f32 v32, 0x3a000000, v32
    s_waitcnt lgkmcnt(6)
    v_mfma_f32_32x32x16_bf16 v[80:95], v[116:119], a[20:23], v[80:95]
    ds_read_b64_tr_b16 v[108:109], v17 offset:14336
    ds_read_b64_tr_b16 v[110:111], v17 offset:14848
    v_mul_f32 v33, v32, v36
    v_mov_b32 v188, v33
    s_barrier
    s_waitcnt lgkmcnt(6)
    v_mfma_f32_32x32x16_bf16 v[64:79], v[96:99], a[24:27], v[64:79]
    ds_read_b64_tr_b16 v[112:113], v16 offset:16384
    ds_read_b64_tr_b16 v[114:115], v16 offset:16896
    v_add_f32 v189, v32, v33
    v_fmamk_f32 v190, v32, 0x40000000, v33
    s_waitcnt lgkmcnt(6)
    v_mfma_f32_32x32x16_bf16 v[80:95], v[100:103], a[24:27], v[80:95]
    ds_read_b64_tr_b16 v[116:117], v17 offset:16384
    ds_read_b64_tr_b16 v[118:119], v17 offset:16896
    v_fmamk_f32 v191, v32, 0x40400000, v33
    v_cos_f32 v176, v184
    s_waitcnt lgkmcnt(6)
    v_mfma_f32_32x32x16_bf16 v[64:79], v[104:107], a[28:31], v[64:79]
    ds_read_b64_tr_b16 v[96:97], v16 offset:18432
    ds_read_b64_tr_b16 v[98:99], v16 offset:18944
    v_sin_f32 v184, v184
    v_cos_f32 v177, v185
    s_waitcnt lgkmcnt(6)
    v_mfma_f32_32x32x16_bf16 v[80:95], v[108:111], a[28:31], v[80:95]
    ds_read_b64_tr_b16 v[100:101], v17 offset:18432
    ds_read_b64_tr_b16 v[102:103], v17 offset:18944
    v_sin_f32 v185, v185
    v_cos_f32 v178, v186
    s_waitcnt lgkmcnt(6)
    v_mfma_f32_32x32x16_bf16 v[64:79], v[112:115], a[32:35], v[64:79]
    ds_read_b64_tr_b16 v[104:105], v16 offset:20480
    ds_read_b64_tr_b16 v[106:107], v16 offset:20992
    v_sin_f32 v186, v186
    v_cos_f32 v179, v187
    s_waitcnt lgkmcnt(6)
    v_mfma_f32_32x32x16_bf16 v[80:95], v[116:119], a[32:35], v[80:95]
    ds_read_b64_tr_b16 v[108:109], v17 offset:20480
    ds_read_b64_tr_b16 v[110:111], v17 offset:20992
    v_sin_f32 v187, v187
    v_cos_f32 v180, v188
    s_waitcnt lgkmcnt(6)
    v_mfma_f32_32x32x16_bf16 v[64:79], v[96:99], a[36:39], v[64:79]
    ds_read_b64_tr_b16 v[112:113], v16 offset:22528
    ds_read_b64_tr_b16 v[114:115], v16 offset:23040
    v_sin_f32 v188, v188
    v_cos_f32 v181, v189
    s_waitcnt lgkmcnt(6)
    v_mfma_f32_32x32x16_bf16 v[80:95], v[100:103], a[36:39], v[80:95]
    ds_read_b64_tr_b16 v[116:117], v17 offset:22528
    ds_read_b64_tr_b16 v[118:119], v17 offset:23040
    v_sin_f32 v189, v189
    v_cos_f32 v182, v190
    s_waitcnt lgkmcnt(6)
    v_mfma_f32_32x32x16_bf16 v[64:79], v[104:107], a[40:43], v[64:79]
    ds_read_b64_tr_b16 v[96:97], v16 offset:24576
    ds_read_b64_tr_b16 v[98:99], v16 offset:25088
    v_sin_f32 v190, v190
    v_cos_f32 v183, v191
    s_waitcnt lgkmcnt(6)
    v_mfma_f32_32x32x16_bf16 v[80:95], v[108:111], a[40:43], v[80:95]
    ds_read_b64_tr_b16 v[100:101], v17 offset:24576
    ds_read_b64_tr_b16 v[102:103], v17 offset:25088
    v_sin_f32 v191, v191
    v_add_f32 v32, v38, v35
    s_waitcnt lgkmcnt(6)
    v_mfma_f32_32x32x16_bf16 v[64:79], v[112:115], a[44:47], v[64:79]
    ds_read_b64_tr_b16 v[104:105], v16 offset:26624
    ds_read_b64_tr_b16 v[106:107], v16 offset:27136
    v_mul_f32 v32, 0x3c800000, v32
    v_mul_f32 v33, v32, v34
    s_waitcnt lgkmcnt(6)
    v_mfma_f32_32x32x16_bf16 v[80:95], v[116:119], a[44:47], v[80:95]
    ds_read_b64_tr_b16 v[108:109], v17 offset:26624
    ds_read_b64_tr_b16 v[110:111], v17 offset:27136
    v_mov_b32 v44, v33
    v_add_f32 v45, v32, v33
    s_waitcnt lgkmcnt(6)
    v_mfma_f32_32x32x16_bf16 v[64:79], v[96:99], a[48:51], v[64:79]
    ds_read_b64_tr_b16 v[112:113], v16 offset:28672
    ds_read_b64_tr_b16 v[114:115], v16 offset:29184
    v_fmamk_f32 v46, v32, 0x40000000, v33
    v_fmamk_f32 v47, v32, 0x40400000, v33
    s_waitcnt lgkmcnt(6)
    v_mfma_f32_32x32x16_bf16 v[80:95], v[100:103], a[48:51], v[80:95]
    ds_read_b64_tr_b16 v[116:117], v17 offset:28672
    ds_read_b64_tr_b16 v[118:119], v17 offset:29184
    v_cos_f32 v40, v44
    v_sin_f32 v44, v44
    s_waitcnt lgkmcnt(6)
    v_mfma_f32_32x32x16_bf16 v[64:79], v[104:107], a[52:55], v[64:79]
    ds_read_b64_tr_b16 v[96:97], v16 offset:30720
    ds_read_b64_tr_b16 v[98:99], v16 offset:31232
    v_cos_f32 v41, v45
    v_sin_f32 v45, v45
    s_waitcnt lgkmcnt(6)
    v_mfma_f32_32x32x16_bf16 v[80:95], v[108:111], a[52:55], v[80:95]
    ds_read_b64_tr_b16 v[100:101], v17 offset:30720
    ds_read_b64_tr_b16 v[102:103], v17 offset:31232
    v_cos_f32 v42, v46
    v_sin_f32 v46, v46
    s_barrier
    s_waitcnt lgkmcnt(6)
    v_mfma_f32_32x32x16_bf16 v[64:79], v[112:115], a[56:59], v[64:79]
    ds_read_b64_tr_b16 v[104:105], v16 offset:32768
    ds_read_b64_tr_b16 v[106:107], v16 offset:33280
    v_cos_f32 v43, v47
    v_sin_f32 v47, v47
    s_waitcnt lgkmcnt(6)
    v_mfma_f32_32x32x16_bf16 v[80:95], v[116:119], a[56:59], v[80:95]
    ds_read_b64_tr_b16 v[108:109], v17 offset:32768
    ds_read_b64_tr_b16 v[110:111], v17 offset:33280
    v_cvt_pk_bf16_f32 v120, v40, v41
    v_cvt_pk_bf16_f32 v122, v44, v45
    s_waitcnt lgkmcnt(6)
    v_mfma_f32_32x32x16_bf16 v[64:79], v[96:99], a[60:63], v[64:79]
    ds_read_b64_tr_b16 v[112:113], v16 offset:34816
    ds_read_b64_tr_b16 v[114:115], v16 offset:35328
    v_cvt_pk_bf16_f32 v121, v42, v43
    v_cvt_pk_bf16_f32 v123, v46, v47
    s_waitcnt lgkmcnt(6)
    v_mfma_f32_32x32x16_bf16 v[80:95], v[100:103], a[60:63], v[80:95]
    ds_read_b64_tr_b16 v[116:117], v17 offset:34816
    ds_read_b64_tr_b16 v[118:119], v17 offset:35328
    v_mul_f32 v32, 0x3d000000, v32
    v_mul_f32 v33, 0x3d000000, v33
    s_waitcnt lgkmcnt(6)
    v_mfma_f32_32x32x16_bf16 v[64:79], v[104:107], v[128:131], v[64:79]
    ds_read_b64_tr_b16 v[96:97], v16 offset:36864
    ds_read_b64_tr_b16 v[98:99], v16 offset:37376
    v_mov_b32 v56, v33
    v_add_f32 v57, v32, v33
    s_waitcnt lgkmcnt(6)
    v_mfma_f32_32x32x16_bf16 v[80:95], v[108:111], v[128:131], v[80:95]
    ds_read_b64_tr_b16 v[100:101], v17 offset:36864
    ds_read_b64_tr_b16 v[102:103], v17 offset:37376
    v_fmamk_f32 v58, v32, 0x40000000, v33
    v_fmamk_f32 v59, v32, 0x40400000, v33
    s_waitcnt lgkmcnt(6)
    v_mfma_f32_32x32x16_bf16 v[64:79], v[112:115], v[132:135], v[64:79]
    ds_read_b64_tr_b16 v[104:105], v16 offset:38912
    ds_read_b64_tr_b16 v[106:107], v16 offset:39424
    v_fmamk_f32 v60, v32, 0x41800000, v33
    v_fmamk_f32 v61, v32, 0x41880000, v33
    s_waitcnt lgkmcnt(6)
    v_mfma_f32_32x32x16_bf16 v[80:95], v[116:119], v[132:135], v[80:95]
    ds_read_b64_tr_b16 v[108:109], v17 offset:38912
    ds_read_b64_tr_b16 v[110:111], v17 offset:39424
    v_fmamk_f32 v62, v32, 0x41900000, v33
    v_fmamk_f32 v63, v32, 0x41980000, v33
    s_waitcnt vmcnt(0)
    v_mov_b32 v26, s71
    s_mov_b64 exec, 1
    buffer_store_dword v26, v7, s[48:51], s22 offen sc1
    s_mov_b64 exec, -1
    s_waitcnt lgkmcnt(6)
    v_mfma_f32_32x32x16_bf16 v[64:79], v[96:99], v[136:139], v[64:79]
    ds_read_b64_tr_b16 v[112:113], v16 offset:40960
    ds_read_b64_tr_b16 v[114:115], v16 offset:41472
    v_cos_f32 v48, v56
    v_sin_f32 v56, v56
    s_waitcnt lgkmcnt(6)
    v_mfma_f32_32x32x16_bf16 v[80:95], v[100:103], v[136:139], v[80:95]
    ds_read_b64_tr_b16 v[116:117], v17 offset:40960
    ds_read_b64_tr_b16 v[118:119], v17 offset:41472
    v_cos_f32 v49, v57
    v_sin_f32 v57, v57
    s_waitcnt lgkmcnt(6)
    v_mfma_f32_32x32x16_bf16 v[64:79], v[104:107], v[140:143], v[64:79]
    ds_read_b64_tr_b16 v[96:97], v16 offset:43008
    ds_read_b64_tr_b16 v[98:99], v16 offset:43520
    v_cos_f32 v50, v58
    v_sin_f32 v58, v58
    s_waitcnt lgkmcnt(6)
    v_mfma_f32_32x32x16_bf16 v[80:95], v[108:111], v[140:143], v[80:95]
    ds_read_b64_tr_b16 v[100:101], v17 offset:43008
    ds_read_b64_tr_b16 v[102:103], v17 offset:43520
    v_cos_f32 v51, v59
    v_sin_f32 v59, v59
    s_waitcnt lgkmcnt(6)
    v_mfma_f32_32x32x16_bf16 v[64:79], v[112:115], v[144:147], v[64:79]
    ds_read_b64_tr_b16 v[104:105], v16 offset:45056
    ds_read_b64_tr_b16 v[106:107], v16 offset:45568
    v_cos_f32 v52, v60
    v_sin_f32 v60, v60
    s_waitcnt lgkmcnt(6)
    v_mfma_f32_32x32x16_bf16 v[80:95], v[116:119], v[144:147], v[80:95]
    ds_read_b64_tr_b16 v[108:109], v17 offset:45056
    ds_read_b64_tr_b16 v[110:111], v17 offset:45568
    v_cos_f32 v53, v61
    v_sin_f32 v61, v61
    s_waitcnt lgkmcnt(6)
    v_mfma_f32_32x32x16_bf16 v[64:79], v[96:99], v[148:151], v[64:79]
    ds_read_b64_tr_b16 v[112:113], v16 offset:47104
    ds_read_b64_tr_b16 v[114:115], v16 offset:47616
    v_cos_f32 v54, v62
    v_sin_f32 v62, v62
    s_waitcnt lgkmcnt(6)
    v_mfma_f32_32x32x16_bf16 v[80:95], v[100:103], v[148:151], v[80:95]
    ds_read_b64_tr_b16 v[116:117], v17 offset:47104
    ds_read_b64_tr_b16 v[118:119], v17 offset:47616
    v_cos_f32 v55, v63
    v_sin_f32 v63, v63
    s_barrier
    s_waitcnt lgkmcnt(6)
    v_mfma_f32_32x32x16_bf16 v[64:79], v[104:107], v[152:155], v[64:79]
    ds_read_b64_tr_b16 v[96:97], v16 offset:49152
    ds_read_b64_tr_b16 v[98:99], v16 offset:49664
    v_mul_f32 v32, 0x3d000000, v35
    v_mul_f32 v33, v32, v34
    s_waitcnt lgkmcnt(6)
    v_mfma_f32_32x32x16_bf16 v[80:95], v[108:111], v[152:155], v[80:95]
    ds_read_b64_tr_b16 v[100:101], v17 offset:49152
    ds_read_b64_tr_b16 v[102:103], v17 offset:49664
    v_mov_b32 v44, v33
    v_add_f32 v45, v32, v33
    s_waitcnt lgkmcnt(6)
    v_mfma_f32_32x32x16_bf16 v[64:79], v[112:115], v[156:159], v[64:79]
    ds_read_b64_tr_b16 v[104:105], v16 offset:51200
    ds_read_b64_tr_b16 v[106:107], v16 offset:51712
    v_fmamk_f32 v46, v32, 0x40000000, v33
    v_fmamk_f32 v47, v32, 0x40400000, v33
    s_waitcnt lgkmcnt(6)
    v_mfma_f32_32x32x16_bf16 v[80:95], v[116:119], v[156:159], v[80:95]
    ds_read_b64_tr_b16 v[108:109], v17 offset:51200
    ds_read_b64_tr_b16 v[110:111], v17 offset:51712
    v_cos_f32 v40, v44
    v_sin_f32 v44, v44
    s_waitcnt lgkmcnt(6)
    v_mfma_f32_32x32x16_bf16 v[64:79], v[96:99], v[160:163], v[64:79]
    ds_read_b64_tr_b16 v[112:113], v16 offset:53248
    ds_read_b64_tr_b16 v[114:115], v16 offset:53760
    v_cos_f32 v41, v45
    v_sin_f32 v45, v45
    s_waitcnt lgkmcnt(6)
    v_mfma_f32_32x32x16_bf16 v[80:95], v[100:103], v[160:163], v[80:95]
    ds_read_b64_tr_b16 v[116:117], v17 offset:53248
    ds_read_b64_tr_b16 v[118:119], v17 offset:53760
    v_cos_f32 v42, v46
    v_sin_f32 v46, v46
    s_waitcnt lgkmcnt(6)
    v_mfma_f32_32x32x16_bf16 v[64:79], v[104:107], v[164:167], v[64:79]
    ds_read_b64_tr_b16 v[96:97], v16 offset:55296
    ds_read_b64_tr_b16 v[98:99], v16 offset:55808
    v_cos_f32 v43, v47
    v_sin_f32 v47, v47
    s_waitcnt lgkmcnt(6)
    v_mfma_f32_32x32x16_bf16 v[80:95], v[108:111], v[164:167], v[80:95]
    ds_read_b64_tr_b16 v[100:101], v17 offset:55296
    ds_read_b64_tr_b16 v[102:103], v17 offset:55808
    v_cvt_pk_bf16_f32 v124, v40, v41
    v_cvt_pk_bf16_f32 v126, v44, v45
    s_waitcnt lgkmcnt(6)
    v_mfma_f32_32x32x16_bf16 v[64:79], v[112:115], v[168:171], v[64:79]
    v_cvt_pk_bf16_f32 v125, v42, v43
    v_cvt_pk_bf16_f32 v127, v46, v47
    s_waitcnt lgkmcnt(4)
    v_mfma_f32_32x32x16_bf16 v[80:95], v[116:119], v[168:171], v[80:95]
    v_and_b32 v36, 1, v4
    v_mul_u32_u24 v36, 0x8000, v36
    s_waitcnt lgkmcnt(2)
    v_mfma_f32_32x32x16_bf16 v[64:79], v[96:99], v[172:175], v[64:79]
    v_lshl_or_b32 v36, v36, 16, v36
    v_and_b32 v37, 2, v4
    s_waitcnt lgkmcnt(0)
    v_mfma_f32_32x32x16_bf16 v[80:95], v[100:103], v[172:175], v[80:95]
    v_mul_u32_u24 v37, 0x4000, v37
    v_lshl_or_b32 v37, v37, 16, v37
    v_mov_b32 v29, 159792
    v_mov_b32 v30, 1
    s_mov_b64 exec, 1
    ds_add_u32 v29, v30
    s_mov_b64 exec, -1
    s_nop 0
    v_fma_f32 v128, v64, s88, 1.0
    v_fma_f32 v129, v65, s88, 1.0
    v_fma_f32 v130, v66, s88, 1.0
    v_fma_f32 v131, v67, s88, 1.0
    v_fma_f32 v132, v68, s88, 1.0
    v_fma_f32 v133, v69, s88, 1.0
    v_fma_f32 v134, v70, s88, 1.0
    v_fma_f32 v135, v71, s88, 1.0
    v_exp_f32 v128, v128
    v_exp_f32 v129, v129
    v_exp_f32 v130, v130
    v_exp_f32 v131, v131
    v_exp_f32 v132, v132
    v_exp_f32 v133, v133
    v_exp_f32 v134, v134
    v_exp_f32 v135, v135
    v_add_f32 v128, 1.0, v128
    v_add_f32 v129, 1.0, v129
    v_add_f32 v130, 1.0, v130
    v_add_f32 v131, 1.0, v131
    v_add_f32 v132, 1.0, v132
    v_add_f32 v133, 1.0, v133
    v_add_f32 v134, 1.0, v134
    v_add_f32 v135, 1.0, v135
    v_fma_f32 v136, v128, v128, 1.0
    v_fma_f32 v137, v129, v129, 1.0
    v_fma_f32 v138, v130, v130, 1.0
    v_fma_f32 v139, v131, v131, 1.0
    v_fma_f32 v140, v132, v132, 1.0
    v_fma_f32 v141, v133, v133, 1.0
    v_fma_f32 v142, v134, v134, 1.0
    v_fma_f32 v143, v135, v135, 1.0
    v_rcp_f32 v136, v136
    v_rcp_f32 v137, v137
    v_rcp_f32 v138, v138
    v_rcp_f32 v139, v139
    v_rcp_f32 v140, v140
    v_rcp_f32 v141, v141
    v_rcp_f32 v142, v142
    v_rcp_f32 v143, v143
    v_mul_f32 v128, v128, v136 clamp
    v_mul_f32 v129, v129, v137 clamp
    v_mul_f32 v130, v130, v138 clamp
    v_mul_f32 v131, v131, v139 clamp
    v_mul_f32 v132, v132, v140 clamp
    v_mul_f32 v133, v133, v141 clamp
    v_mul_f32 v134, v134, v142 clamp
    v_mul_f32 v135, v135, v143 clamp
    v_mul_f32 v128, v128, v64
    v_mul_f32 v129, v129, v65
    v_mul_f32 v130, v130, v66
    v_mul_f32 v131, v131, v67
    v_mul_f32 v132, v132, v68
    v_mul_f32 v133, v133, v69
    v_mul_f32 v134, v134, v70
    v_mul_f32 v135, v135, v71
    v_cvt_pk_bf16_f32 v64, v128, v129
    v_cvt_pk_bf16_f32 v65, v130, v131
    v_cvt_pk_bf16_f32 v66, v132, v133
    v_cvt_pk_bf16_f32 v67, v134, v135
    buffer_store_dwordx4 v[64:67], v7, s[48:51], s84 offen offset:0 sc1
    v_fma_f32 v128, v72, s88, 1.0
    v_fma_f32 v129, v73, s88, 1.0
    v_fma_f32 v130, v74, s88, 1.0
    v_fma_f32 v131, v75, s88, 1.0
    v_fma_f32 v132, v76, s88, 1.0
    v_fma_f32 v133, v77, s88, 1.0
    v_fma_f32 v134, v78, s88, 1.0
    v_fma_f32 v135, v79, s88, 1.0
    v_exp_f32 v128, v128
    v_exp_f32 v129, v129
    v_exp_f32 v130, v130
    v_exp_f32 v131, v131
    v_exp_f32 v132, v132
    v_exp_f32 v133, v133
    v_exp_f32 v134, v134
    v_exp_f32 v135, v135
    v_add_f32 v128, 1.0, v128
    v_add_f32 v129, 1.0, v129
    v_add_f32 v130, 1.0, v130
    v_add_f32 v131, 1.0, v131
    v_add_f32 v132, 1.0, v132
    v_add_f32 v133, 1.0, v133
    v_add_f32 v134, 1.0, v134
    v_add_f32 v135, 1.0, v135
    v_fma_f32 v136, v128, v128, 1.0
    v_fma_f32 v137, v129, v129, 1.0
    v_fma_f32 v138, v130, v130, 1.0
    v_fma_f32 v139, v131, v131, 1.0
    v_fma_f32 v140, v132, v132, 1.0
    v_fma_f32 v141, v133, v133, 1.0
    v_mov_b32 v9, s71
    s_mov_b64 exec, -1
    buffer_load_dword v9, v8, s[48:51], 0 offen sc1
    s_mov_b64 exec, -1
    s_load_dwordx16 s[4:19], s[24:25], s20 glc
    v_fma_f32 v142, v134, v134, 1.0
    v_fma_f32 v143, v135, v135, 1.0
    v_rcp_f32 v136, v136
    v_rcp_f32 v137, v137
    v_rcp_f32 v138, v138
    v_rcp_f32 v139, v139
    v_rcp_f32 v140, v140
    v_rcp_f32 v141, v141
    v_rcp_f32 v142, v142
    v_rcp_f32 v143, v143
    v_mul_f32 v128, v128, v136 clamp
    v_mul_f32 v129, v129, v137 clamp
    v_mul_f32 v130, v130, v138 clamp
    v_mul_f32 v131, v131, v139 clamp
    v_mul_f32 v132, v132, v140 clamp
    v_mul_f32 v133, v133, v141 clamp
    v_mul_f32 v134, v134, v142 clamp
    v_mul_f32 v135, v135, v143 clamp
    v_mul_f32 v128, v128, v72
    v_mul_f32 v129, v129, v73
    v_mul_f32 v130, v130, v74
    v_mul_f32 v131, v131, v75
    v_mul_f32 v132, v132, v76
    v_mul_f32 v133, v133, v77
    v_mul_f32 v134, v134, v78
    v_mul_f32 v135, v135, v79
    v_cvt_pk_bf16_f32 v72, v128, v129
    v_cvt_pk_bf16_f32 v73, v130, v131
    v_cvt_pk_bf16_f32 v74, v132, v133
    v_cvt_pk_bf16_f32 v75, v134, v135
    buffer_store_dwordx4 v[72:75], v7, s[48:51], s84 offen offset:1024 sc1
    v_fma_f32 v128, v80, s88, 1.0
    v_fma_f32 v129, v81, s88, 1.0
    v_fma_f32 v130, v82, s88, 1.0
    v_fma_f32 v131, v83, s88, 1.0
    v_fma_f32 v132, v84, s88, 1.0
    v_fma_f32 v133, v85, s88, 1.0
    v_fma_f32 v134, v86, s88, 1.0
    v_fma_f32 v135, v87, s88, 1.0
    v_exp_f32 v128, v128
    v_exp_f32 v129, v129
    v_exp_f32 v130, v130
    v_exp_f32 v131, v131
    v_exp_f32 v132, v132
    v_exp_f32 v133, v133
    v_exp_f32 v134, v134
    v_exp_f32 v135, v135
    v_add_f32 v128, 1.0, v128
    v_add_f32 v129, 1.0, v129
    v_add_f32 v130, 1.0, v130
    v_add_f32 v131, 1.0, v131
    v_add_f32 v132, 1.0, v132
    v_add_f32 v133, 1.0, v133
    v_add_f32 v134, 1.0, v134
    v_add_f32 v135, 1.0, v135
    v_fma_f32 v136, v128, v128, 1.0
    v_fma_f32 v137, v129, v129, 1.0
    v_fma_f32 v138, v130, v130, 1.0
    v_fma_f32 v139, v131, v131, 1.0
    v_fma_f32 v140, v132, v132, 1.0
    v_fma_f32 v141, v133, v133, 1.0
    v_fma_f32 v142, v134, v134, 1.0
    v_fma_f32 v143, v135, v135, 1.0
    v_rcp_f32 v136, v136
    v_rcp_f32 v137, v137
    v_rcp_f32 v138, v138
    v_rcp_f32 v139, v139
    v_rcp_f32 v140, v140
    v_rcp_f32 v141, v141
    v_rcp_f32 v142, v142
    v_rcp_f32 v143, v143
    v_mul_f32 v128, v128, v136 clamp
    v_mul_f32 v129, v129, v137 clamp
    v_mul_f32 v130, v130, v138 clamp
    v_mul_f32 v131, v131, v139 clamp
    v_mul_f32 v132, v132, v140 clamp
    v_mul_f32 v133, v133, v141 clamp
    v_mul_f32 v134, v134, v142 clamp
    v_mul_f32 v135, v135, v143 clamp
    v_mul_f32 v128, v128, v80
    v_mul_f32 v129, v129, v81
    v_mul_f32 v130, v130, v82
    v_mul_f32 v131, v131, v83
    v_mul_f32 v132, v132, v84
    v_mul_f32 v133, v133, v85
    v_mul_f32 v134, v134, v86
    v_mul_f32 v135, v135, v87
    v_cvt_pk_bf16_f32 v80, v128, v129
    v_cvt_pk_bf16_f32 v81, v130, v131
    v_cvt_pk_bf16_f32 v82, v132, v133
    v_cvt_pk_bf16_f32 v83, v134, v135
    s_waitcnt lgkmcnt(0)
    s_or_b64 s[98:99], s[4:5], s[6:7]
    s_and_b64 s[4:5], s[4:5], s[6:7]
    s_or_b64 s[98:99], s[98:99], s[8:9]
    s_and_b64 s[4:5], s[4:5], s[8:9]
    s_or_b64 s[98:99], s[98:99], s[10:11]
    s_and_b64 s[4:5], s[4:5], s[10:11]
    s_or_b64 s[98:99], s[98:99], s[12:13]
    s_and_b64 s[4:5], s[4:5], s[12:13]
    s_or_b64 s[98:99], s[98:99], s[14:15]
    s_and_b64 s[4:5], s[4:5], s[14:15]
    s_or_b64 s[98:99], s[98:99], s[16:17]
    s_and_b64 s[4:5], s[4:5], s[16:17]
    s_or_b64 s[98:99], s[98:99], s[18:19]
    s_and_b64 s[4:5], s[4:5], s[18:19]
    s_xor_b64 s[98:99], s[98:99], s[92:93]
    s_xor_b64 s[4:5], s[4:5], s[92:93]
    s_or_b64 s[4:5], s[4:5], s[98:99]
    s_mov_b32 s76, 0
    s_cbranch_scc1 L_nopre
    s_lshl_b32 s73, s64, 11
    s_cmp_eq_u32 s78, 224
    s_cselect_b32 s74, 0, s78
    s_mul_i32 s74, s74, 8192
    s_add_u32 s74, s74, s73
    s_add_u32 s74, s74, 2097152
    s_add_u32 m0, s73, 131072
    s_nop 0
    buffer_load_dwordx4 v7, s[48:51], s74 offen offset:0 sc1 lds
    buffer_load_dwordx4 v7, s[48:51], s74 offen offset:1024 sc1 lds
    s_mov_b32 s76, 1
    s_waitcnt vmcnt(3)
    s_branch L_pre0
L_nopre:
    s_waitcnt vmcnt(1)
L_pre0:
    v_cmp_ne_u32 vcc, s71, v9
    s_cbranch_vccnz L_nowg
    s_lshl_b32 s73, s64, 11
    s_mul_i32 s72, s78, 8192
    s_add_u32 s22, s72, s73
    s_add_u32 s72, s22, 4194304
    s_add_u32 s74, s73, 65536
    buffer_load_dwordx4 v[104:107], v7, s[48:51], s72 offen offset:0 sc1
    buffer_load_dwordx4 v[108:111], v7, s[48:51], s72 offen offset:1024 sc1
    buffer_load_dwordx4 v[96:99], v7, s[48:51], s74 offen offset:0 sc1
    buffer_load_dwordx4 v[100:103], v7, s[48:51], s74 offen offset:1024 sc1
    s_add_u32 s76, s76, 2
L_nowg:
    buffer_store_dwordx4 v[80:83], v7, s[48:51], s84 offen offset:2048 sc1
    v_fma_f32 v128, v88, s88, 1.0
    v_fma_f32 v129, v89, s88, 1.0
    v_fma_f32 v130, v90, s88, 1.0
    v_fma_f32 v131, v91, s88, 1.0
    v_fma_f32 v132, v92, s88, 1.0
    v_fma_f32 v133, v93, s88, 1.0
    v_fma_f32 v134, v94, s88, 1.0
    v_fma_f32 v135, v95, s88, 1.0
    v_exp_f32 v128, v128
    v_exp_f32 v129, v129
    v_exp_f32 v130, v130
    v_exp_f32 v131, v131
    v_exp_f32 v132, v132
    v_exp_f32 v133, v133
    v_exp_f32 v134, v134
    v_exp_f32 v135, v135
    v_add_f32 v128, 1.0, v128
    v_add_f32 v129, 1.0, v129
    v_add_f32 v130, 1.0, v130
    v_add_f32 v131, 1.0, v131
    v_add_f32 v132, 1.0, v132
    v_add_f32 v133, 1.0, v133
    v_add_f32 v134, 1.0, v134
    v_add_f32 v135, 1.0, v135
    v_fma_f32 v136, v128, v128, 1.0
    v_fma_f32 v137, v129, v129, 1.0
    v_fma_f32 v138, v130, v130, 1.0
    v_fma_f32 v139, v131, v131, 1.0
    v_fma_f32 v140, v132, v132, 1.0
    v_fma_f32 v141, v133, v133, 1.0
    v_fma_f32 v142, v134, v134, 1.0
    v_fma_f32 v143, v135, v135, 1.0
    v_rcp_f32 v136, v136
    v_rcp_f32 v137, v137
    v_rcp_f32 v138, v138
    v_rcp_f32 v139, v139
    v_rcp_f32 v140, v140
    v_rcp_f32 v141, v141
    v_rcp_f32 v142, v142
    v_rcp_f32 v143, v143
    v_mul_f32 v128, v128, v136 clamp
    v_mul_f32 v129, v129, v137 clamp
    v_mul_f32 v130, v130, v138 clamp
    v_mul_f32 v131, v131, v139 clamp
    v_mul_f32 v132, v132, v140 clamp
    v_mul_f32 v133, v133, v141 clamp
    v_mul_f32 v134, v134, v142 clamp
    v_mul_f32 v135, v135, v143 clamp
    v_mul_f32 v128, v128, v88
    v_mul_f32 v129, v129, v89
    v_mul_f32 v130, v130, v90
    v_mul_f32 v131, v131, v91
    v_mul_f32 v132, v132, v92
    v_mul_f32 v133, v133, v93
    v_mul_f32 v134, v134, v94
    v_mul_f32 v135, v135, v95
    v_cvt_pk_bf16_f32 v88, v128, v129
    v_cvt_pk_bf16_f32 v89, v130, v131
    v_cvt_pk_bf16_f32 v90, v132, v133
    v_cvt_pk_bf16_f32 v91, v134, v135
    buffer_store_dwordx4 v[88:91], v7, s[48:51], s84 offen offset:3072 sc1
    s_mov_b32 s85, 0
    v_cmp_ne_u32 vcc, 0, v36
    v_mov_b64 v[130:131], v[120:121]
    v_xor_b32 v128, 0x80008000, v122
    v_mov_b64 v[132:133], v[122:123]
    v_xor_b32 v129, 0x80008000, v123
    v_mov_b64 v[154:155], v[124:125]
    v_xor_b32 v152, 0x80008000, v126
    v_mov_b64 v[156:157], v[126:127]
    v_xor_b32 v153, 0x80008000, v127
    v_cndmask_b32 v136, v130, v128, vcc
    v_cndmask_b32 v138, v132, v130, vcc
    v_cndmask_b32 v137, v131, v129, vcc
    v_cndmask_b32 v139, v133, v131, vcc
    v_xor_b32 v136, v37, v136
    v_xor_b32 v137, v37, v137
    v_xor_b32 v138, v37, v138
    v_xor_b32 v139, v37, v139
    v_xor_b32 v134, 0x80008000, v138
    v_xor_b32 v135, 0x80008000, v139
    v_xor_b32 v140, v36, v128
    v_xor_b32 v141, v36, v129
    v_xor_b32 v142, v36, v130
    v_xor_b32 v143, v36, v131
    v_xor_b32 v144, v36, v132
    v_xor_b32 v145, v36, v133
    v_xor_b32 v146, v36, v134
    v_xor_b32 v147, v36, v135
    v_xor_b32 v148, v36, v136
    v_xor_b32 v149, v36, v137
    v_xor_b32 v150, v36, v138
    v_xor_b32 v151, v36, v139
    v_xor_b32 v158, v36, v152
    v_xor_b32 v159, v36, v153
    v_xor_b32 v160, v36, v154
    v_xor_b32 v161, v36, v155
    v_xor_b32 v162, v36, v156
    v_xor_b32 v163, v36, v157
    v_xor_b32 v164, 0x80000000, v152
    v_xor_b32 v165, 0x80000000, v153
    v_xor_b32 v166, 0x80000000, v154
    v_xor_b32 v167, 0x80000000, v155
    v_xor_b32 v168, 0x80000000, v156
    v_xor_b32 v169, 0x80000000, v157
    v_xor_b32 v170, 0x80000000, v158
    v_xor_b32 v171, 0x80000000, v159
    v_xor_b32 v172, 0x80000000, v160
    v_xor_b32 v173, 0x80000000, v161
    v_xor_b32 v174, 0x80000000, v162
    v_xor_b32 v175, 0x80000000, v163
    s_cmp_eq_u32 s76, 3
    s_cbranch_scc1 L_pre2
    v_mov_b32 v9, s71
    s_mov_b64 exec, -1
    buffer_load_dword v9, v8, s[48:51], 0 offen sc1
    s_mov_b64 exec, -1
    s_load_dwordx16 s[4:19], s[24:25], s20 glc
    s_cmp_lg_u32 s85, 0
    s_cbranch_scc1 L_ts1
    s_waitcnt vmcnt(0)
    v_mov_b32 v26, s71
    s_mov_b64 exec, 1
    buffer_store_dword v26, v7, s[48:51], s77 offen sc1
    s_mov_b64 exec, -1
    s_mov_b32 s85, 1
L_ts1:
    s_waitcnt vmcnt(1)
    v_cmp_ne_u32 vcc, s71, v9
    s_cbranch_vccz poll2_ok
    s_mov_b32 s79, 20000
poll2:
    buffer_load_dword v9, v8, s[48:51], 0 offen sc1
    s_mov_b64 exec, -1
    s_waitcnt vmcnt(0)
    v_cmp_ne_u32 vcc, s71, v9
    s_cbranch_vccz poll2_ok
    s_sleep 4
    s_sub_u32 s79, s79, 1
    s_cbranch_scc0 poll2
poll2_ok:
    s_lshl_b32 s73, s64, 11
    s_mul_i32 s72, s78, 8192
    s_add_u32 s22, s72, s73
    s_add_u32 s72, s22, 4194304
    s_add_u32 s74, s73, 65536
    buffer_load_dwordx4 v[104:107], v7, s[48:51], s72 offen offset:0 sc1
    buffer_load_dwordx4 v[108:111], v7, s[48:51], s72 offen offset:1024 sc1
    buffer_load_dwordx4 v[96:99], v7, s[48:51], s74 offen offset:0 sc1
    buffer_load_dwordx4 v[100:103], v7, s[48:51], s74 offen offset:1024 sc1
L_p2:
    s_mov_b32 s79, 20000
sp3:
    s_waitcnt lgkmcnt(0)
    s_or_b64 s[98:99], s[4:5], s[6:7]
    s_and_b64 s[4:5], s[4:5], s[6:7]
    s_or_b64 s[98:99], s[98:99], s[8:9]
    s_and_b64 s[4:5], s[4:5], s[8:9]
    s_or_b64 s[98:99], s[98:99], s[10:11]
    s_and_b64 s[4:5], s[4:5], s[10:11]
    s_or_b64 s[98:99], s[98:99], s[12:13]
    s_and_b64 s[4:5], s[4:5], s[12:13]
    s_or_b64 s[98:99], s[98:99], s[14:15]
    s_and_b64 s[4:5], s[4:5], s[14:15]
    s_or_b64 s[98:99], s[98:99], s[16:17]
    s_and_b64 s[4:5], s[4:5], s[16:17]
    s_or_b64 s[98:99], s[98:99], s[18:19]
    s_and_b64 s[4:5], s[4:5], s[18:19]
    s_xor_b64 s[98:99], s[98:99], s[92:93]
    s_xor_b64 s[4:5], s[4:5], s[92:93]
    s_or_b64 s[4:5], s[4:5], s[98:99]
    s_cbranch_scc0 sp3_ok
    s_sleep 2
    s_load_dwordx16 s[4:19], s[24:25], s20 glc
    s_sub_u32 s79, s79, 1
    s_cbranch_scc0 sp3
    s_waitcnt lgkmcnt(0)
sp3_ok:
    s_lshl_b32 s73, s64, 11
    s_cmp_eq_u32 s78, 224
    s_cselect_b32 s74, 0, s78
    s_mul_i32 s74, s74, 8192
    s_add_u32 s74, s74, s73
    s_add_u32 s74, s74, 2097152
    s_add_u32 m0, s73, 131072
    s_nop 0
    buffer_load_dwordx4 v7, s[48:51], s74 offen offset:0 sc1 lds
    buffer_load_dwordx4 v7, s[48:51], s74 offen offset:1024 sc1 lds
    s_waitcnt vmcnt(0)
L_pre2:
    s_waitcnt vmcnt(2)
    s_cmp_lg_u32 s85, 0
    s_cbranch_scc1 L_ts4
    s_getreg_b32 s72, hwreg(HW_REG_IB_STS)
    s_and_b32 s72, s72, 0xc000000f
    s_cmp_gt_u32 s72, 0
    s_cbranch_scc1 L_ts4
    s_waitcnt vmcnt(0)
    v_mov_b32 v26, s71
    s_mov_b64 exec, 1
    buffer_store_dword v26, v7, s[48:51], s77 offen sc1
    s_mov_b64 exec, -1
    s_mov_b32 s85, 1
L_ts4:
    s_mov_b32 s74, s22
    v_add_u32 v6, 131072, v7
    s_mov_b32 s87, 0x36124925
    v_mov_b32 v29, 159744
    v_mov_b32 v30, 1
    s_mov_b64 exec, 1
    ds_add_u32 v29, v30
    s_mov_b64 exec, -1
    v_mov_b32 v29, 159744
    s_mov_b32 s79, 1280000
swb5:
    s_cmp_lg_u32 s85, 0
    s_cbranch_scc1 L_ts6
    s_getreg_b32 s72, hwreg(HW_REG_IB_STS)
    s_and_b32 s72, s72, 0xc000000f
    s_cmp_gt_u32 s72, 0
    s_cbranch_scc1 L_ts6
    s_waitcnt vmcnt(0)
    v_mov_b32 v26, s71
    s_mov_b64 exec, 1
    buffer_store_dword v26, v7, s[48:51], s77 offen sc1
    s_mov_b64 exec, -1
    s_mov_b32 s85, 1
L_ts6:
    ds_read_b32 v30, v29
    s_waitcnt lgkmcnt(0)
    v_cmp_gt_u32 vcc, 4, v30
    s_cbranch_vccz swb5_ok
    s_sleep 1
    s_sub_u32 s79, s79, 1
    s_cbranch_scc0 swb5
swb5_ok:
    s_cmp_eq_u32 s78, 0
    s_cbranch_scc1 L_real
    s_cmp_eq_u32 s78, 224
    s_cbranch_scc1 L_real1
    ds_read_b128 a[0:3], v6 offset:0
    ds_read_b128 a[4:7], v6 offset:1024
    ds_read_b128 a[8:11], v6 offset:2048
    ds_read_b128 a[12:15], v6 offset:3072
    ds_read_b128 a[16:19], v6 offset:4096
    ds_read_b128 a[20:23], v6 offset:5120
    ds_read_b128 a[24:27], v6 offset:6144
    ds_read_b128 a[28:31], v6 offset:7168
    s_branch L_go
L_real1:
    v_add_u32 v6, 8, v6
L_real:
    ds_read_b64 a[0:1], v6 offset:0
    ds_read_b64 a[4:5], v6 offset:1024
    ds_read_b64 a[8:9], v6 offset:2048
    ds_read_b64 a[12:13], v6 offset:3072
    ds_read_b64 a[16:17], v6 offset:4096
    ds_read_b64 a[20:21], v6 offset:5120
    ds_read_b64 a[24:25], v6 offset:6144
    ds_read_b64 a[28:29], v6 offset:7168
    v_accvgpr_write_b32 a2, 0
    v_accvgpr_write_b32 a3, 0
    v_accvgpr_write_b32 a6, 0
    v_accvgpr_write_b32 a7, 0
    v_accvgpr_write_b32 a10, 0
    v_accvgpr_write_b32 a11, 0
    v_accvgpr_write_b32 a14, 0
    v_accvgpr_write_b32 a15, 0
    v_accvgpr_write_b32 a18, 0
    v_accvgpr_write_b32 a19, 0
    v_accvgpr_write_b32 a22, 0
    v_accvgpr_write_b32 a23, 0
    v_accvgpr_write_b32 a26, 0
    v_accvgpr_write_b32 a27, 0
    v_accvgpr_write_b32 a30, 0
    v_accvgpr_write_b32 a31, 0
    s_mov_b32 s87, 0x35924925
L_go:
    s_waitcnt lgkmcnt(6)
    v_mfma_f32_16x16x32_bf16 v[64:67], a[0:3], v[130:133], 0
    v_mfma_f32_16x16x32_bf16 v[72:75], a[0:3], v[128:131], 0
    v_mfma_f32_16x16x32_bf16 v[68:71], a[4:7], v[130:133], 0
    v_mfma_f32_16x16x32_bf16 v[76:79], a[4:7], v[128:131], 0
    s_waitcnt lgkmcnt(4)
    v_mfma_f32_16x16x32_bf16 v[64:67], a[8:11], v[136:139], v[64:67]
    v_mfma_f32_16x16x32_bf16 v[72:75], a[8:11], v[134:137], v[72:75]
    v_mfma_f32_16x16x32_bf16 v[68:71], a[12:15], v[136:139], v[68:71]
    v_mfma_f32_16x16x32_bf16 v[76:79], a[12:15], v[134:137], v[76:79]
    s_waitcnt lgkmcnt(2)
    v_mfma_f32_16x16x32_bf16 v[64:67], a[16:19], v[142:145], v[64:67]
    v_mfma_f32_16x16x32_bf16 v[72:75], a[16:19], v[140:143], v[72:75]
    v_mfma_f32_16x16x32_bf16 v[68:71], a[20:23], v[142:145], v[68:71]
    v_mfma_f32_16x16x32_bf16 v[76:79], a[20:23], v[140:143], v[76:79]
    s_waitcnt lgkmcnt(0)
    v_mfma_f32_16x16x32_bf16 v[64:67], a[24:27], v[148:151], v[64:67]
    v_mfma_f32_16x16x32_bf16 v[72:75], a[24:27], v[146:149], v[72:75]
    v_mfma_f32_16x16x32_bf16 v[68:71], a[28:31], v[148:151], v[68:71]
    v_mfma_f32_16x16x32_bf16 v[76:79], a[28:31], v[146:149], v[76:79]
    s_cmp_lg_u32 s85, 0
    s_cbranch_scc1 L_ts7
    s_getreg_b32 s72, hwreg(HW_REG_IB_STS)
    s_and_b32 s72, s72, 0xc000000f
    s_cmp_gt_u32 s72, 0
    s_cbranch_scc1 L_ts7
    s_waitcnt vmcnt(0)
    v_mov_b32 v26, s71
    s_mov_b64 exec, 1
    buffer_store_dword v26, v7, s[48:51], s77 offen sc1
    s_mov_b64 exec, -1
    s_mov_b32 s85, 1
L_ts7:
    s_nop 2
    v_pk_mul_f32 v[32:33], v[64:65], v[48:49]
    v_pk_mul_f32 v[40:41], v[72:73], v[48:49]
    v_pk_fma_f32 v[32:33], v[72:73], v[56:57], v[32:33]
    v_pk_fma_f32 v[40:41], v[64:65], v[56:57], v[40:41] neg_lo:[0,1,0] neg_hi:[0,1,0]
    v_pk_mul_f32 v[34:35], v[66:67], v[50:51]
    v_pk_mul_f32 v[42:43], v[74:75], v[50:51]
    v_pk_fma_f32 v[34:35], v[74:75], v[58:59], v[34:35]
    v_pk_fma_f32 v[42:43], v[66:67], v[58:59], v[42:43] neg_lo:[0,1,0] neg_hi:[0,1,0]
    v_pk_mul_f32 v[36:37], v[68:69], v[52:53]
    v_pk_mul_f32 v[44:45], v[76:77], v[52:53]
    v_pk_fma_f32 v[36:37], v[76:77], v[60:61], v[36:37]
    v_pk_fma_f32 v[44:45], v[68:69], v[60:61], v[44:45] neg_lo:[0,1,0] neg_hi:[0,1,0]
    v_pk_mul_f32 v[38:39], v[70:71], v[54:55]
    v_pk_mul_f32 v[46:47], v[78:79], v[54:55]
    v_pk_fma_f32 v[38:39], v[78:79], v[62:63], v[38:39]
    v_pk_fma_f32 v[46:47], v[70:71], v[62:63], v[46:47] neg_lo:[0,1,0] neg_hi:[0,1,0]
    v_cvt_pk_bf16_f32 v80, v32, v33
    v_cvt_pk_bf16_f32 v82, v40, v41
    v_cvt_pk_bf16_f32 v81, v34, v35
    v_cvt_pk_bf16_f32 v83, v42, v43
    v_cvt_pk_bf16_f32 v84, v36, v37
    v_cvt_pk_bf16_f32 v86, v44, v45
    v_cvt_pk_bf16_f32 v85, v38, v39
    v_cvt_pk_bf16_f32 v87, v46, v47
    v_mfma_f32_16x16x32_bf16 v[64:67], v[154:157], v[80:83], 0
    v_mfma_f32_16x16x32_bf16 v[72:75], v[152:155], v[80:83], 0
    v_mfma_f32_16x16x32_bf16 v[68:71], v[166:169], v[80:83], 0
    v_mfma_f32_16x16x32_bf16 v[76:79], v[164:167], v[80:83], 0
    v_mfma_f32_16x16x32_bf16 v[64:67], v[160:163], v[84:87], v[64:67]
    v_mfma_f32_16x16x32_bf16 v[72:75], v[158:161], v[84:87], v[72:75]
    v_mfma_f32_16x16x32_bf16 v[68:71], v[172:175], v[84:87], v[68:71]
    v_mfma_f32_16x16x32_bf16 v[76:79], v[170:173], v[84:87], v[76:79]
    s_cmp_lg_u32 s85, 0
    s_cbranch_scc1 L_ts8
    s_getreg_b32 s72, hwreg(HW_REG_IB_STS)
    s_and_b32 s72, s72, 0xc000000f
    s_cmp_gt_u32 s72, 0
    s_cbranch_scc1 L_ts8
    s_waitcnt vmcnt(0)
    v_mov_b32 v26, s71
    s_mov_b64 exec, 1
    buffer_store_dword v26, v7, s[48:51], s77 offen sc1
    s_mov_b64 exec, -1
    s_mov_b32 s85, 1
L_ts8:
    v_lshlrev_b32 v48, 16, v104
    v_and_b32 v56, 0xffff0000, v104
    v_lshlrev_b32 v49, 16, v105
    v_and_b32 v57, 0xffff0000, v105
    v_lshlrev_b32 v50, 16, v106
    v_and_b32 v58, 0xffff0000, v106
    v_lshlrev_b32 v51, 16, v107
    v_and_b32 v59, 0xffff0000, v107
    v_lshlrev_b32 v52, 16, v108
    v_and_b32 v60, 0xffff0000, v108
    v_lshlrev_b32 v53, 16, v109
    v_and_b32 v61, 0xffff0000, v109
    v_lshlrev_b32 v54, 16, v110
    v_and_b32 v62, 0xffff0000, v110
    v_lshlrev_b32 v55, 16, v111
    v_and_b32 v63, 0xffff0000, v111
    v_mul_f32 v96, s87, v96
    v_mul_f32 v97, s87, v97
    v_mul_f32 v98, s87, v98
    v_mul_f32 v99, s87, v99
    v_mul_f32 v100, s87, v100
    v_mul_f32 v101, s87, v101
    v_mul_f32 v102, s87, v102
    v_mul_f32 v103, s87, v103
    v_pk_mul_f32 v[32:33], v[64:65], v[48:49]
    v_pk_mul_f32 v[40:41], v[72:73], v[48:49]
    v_pk_fma_f32 v[32:33], v[72:73], v[56:57], v[32:33] neg_lo:[0,1,0] neg_hi:[0,1,0]
    v_pk_fma_f32 v[40:41], v[64:65], v[56:57], v[40:41]
    v_pk_mul_f32 v[34:35], v[66:67], v[50:51]
    v_pk_mul_f32 v[42:43], v[74:75], v[50:51]
    v_pk_fma_f32 v[34:35], v[74:75], v[58:59], v[34:35] neg_lo:[0,1,0] neg_hi:[0,1,0]
    v_pk_fma_f32 v[42:43], v[66:67], v[58:59], v[42:43]
    v_pk_mul_f32 v[36:37], v[68:69], v[52:53]
    v_pk_mul_f32 v[44:45], v[76:77], v[52:53]
    v_pk_fma_f32 v[36:37], v[76:77], v[60:61], v[36:37] neg_lo:[0,1,0] neg_hi:[0,1,0]
    v_pk_fma_f32 v[44:45], v[68:69], v[60:61], v[44:45]
    v_pk_mul_f32 v[38:39], v[70:71], v[54:55]
    v_pk_mul_f32 v[46:47], v[78:79], v[54:55]
    v_pk_fma_f32 v[38:39], v[78:79], v[62:63], v[38:39] neg_lo:[0,1,0] neg_hi:[0,1,0]
    v_pk_fma_f32 v[46:47], v[70:71], v[62:63], v[46:47]
    v_cvt_pk_bf16_f32 v80, v40, v41
    v_cvt_pk_bf16_f32 v82, v32, v33
    v_cvt_pk_bf16_f32 v81, v42, v43
    v_cvt_pk_bf16_f32 v83, v34, v35
    v_cvt_pk_bf16_f32 v84, v44, v45
    v_cvt_pk_bf16_f32 v86, v36, v37
    v_cvt_pk_bf16_f32 v85, v46, v47
    v_cvt_pk_bf16_f32 v87, v38, v39
    v_mfma_f32_16x16x32_bf16 v[72:75], v[80:83], v[154:157], 0
    v_mfma_f32_16x16x32_bf16 v[64:67], v[80:83], v[152:155], 0
    v_mfma_f32_16x16x32_bf16 v[76:79], v[80:83], v[166:169], 0
    v_mfma_f32_16x16x32_bf16 v[68:71], v[80:83], v[164:167], 0
    v_mfma_f32_16x16x32_bf16 v[72:75], v[84:87], v[160:163], v[72:75]
    v_mfma_f32_16x16x32_bf16 v[64:67], v[84:87], v[158:161], v[64:67]
    v_mfma_f32_16x16x32_bf16 v[76:79], v[84:87], v[172:175], v[76:79]
    v_mfma_f32_16x16x32_bf16 v[68:71], v[84:87], v[170:173], v[68:71]
    s_cmp_lg_u32 s85, 0
    s_cbranch_scc1 L_ts9
    s_getreg_b32 s72, hwreg(HW_REG_IB_STS)
    s_and_b32 s72, s72, 0xc000000f
    s_cmp_gt_u32 s72, 0
    s_cbranch_scc1 L_ts9
    s_waitcnt vmcnt(0)
    v_mov_b32 v26, s71
    s_mov_b64 exec, 1
    buffer_store_dword v26, v7, s[48:51], s77 offen sc1
    s_mov_b64 exec, -1
    s_mov_b32 s85, 1
L_ts9:
    s_lshl_b32 s72, s64, 11
    v_add_u32 v6, 150528, v7
    v_add_u32 v24, s72, v6
    s_nop 0
    v_pk_mul_f32 v[32:33], v[64:65], v[176:177]
    v_pk_mul_f32 v[40:41], v[72:73], v[176:177]
    v_pk_fma_f32 v[32:33], v[72:73], v[184:185], v[32:33] neg_lo:[0,1,0] neg_hi:[0,1,0]
    v_pk_fma_f32 v[40:41], v[64:65], v[184:185], v[40:41]
    v_pk_mul_f32 v[34:35], v[66:67], v[178:179]
    v_pk_mul_f32 v[42:43], v[74:75], v[178:179]
    v_pk_fma_f32 v[34:35], v[74:75], v[186:187], v[34:35] neg_lo:[0,1,0] neg_hi:[0,1,0]
    v_pk_fma_f32 v[42:43], v[66:67], v[186:187], v[42:43]
    v_pk_mul_f32 v[36:37], v[68:69], v[180:181]
    v_pk_mul_f32 v[44:45], v[76:77], v[180:181]
    v_pk_fma_f32 v[36:37], v[76:77], v[188:189], v[36:37] neg_lo:[0,1,0] neg_hi:[0,1,0]
    v_pk_fma_f32 v[44:45], v[68:69], v[188:189], v[44:45]
    v_pk_mul_f32 v[38:39], v[70:71], v[182:183]
    v_pk_mul_f32 v[46:47], v[78:79], v[182:183]
    v_pk_fma_f32 v[38:39], v[78:79], v[190:191], v[38:39] neg_lo:[0,1,0] neg_hi:[0,1,0]
    v_pk_fma_f32 v[46:47], v[70:71], v[190:191], v[46:47]
    v_cvt_pk_bf16_f32 v80, v40, v41
    v_cvt_pk_bf16_f32 v82, v32, v33
    v_cvt_pk_bf16_f32 v81, v42, v43
    v_cvt_pk_bf16_f32 v83, v34, v35
    v_cvt_pk_bf16_f32 v84, v44, v45
    v_cvt_pk_bf16_f32 v86, v36, v37
    v_cvt_pk_bf16_f32 v85, v46, v47
    v_cvt_pk_bf16_f32 v87, v38, v39
    ds_write_b128 v24, v[80:83]
    ds_write_b128 v24, v[84:87] offset:1024
    v_mov_b32 v29, 159748
    v_mov_b32 v30, 1
    s_mov_b64 exec, 1
    ds_add_u32 v29, v30
    s_mov_b64 exec, -1
    s_mul_i32 s73, s23, 7
    s_lshl_b32 s20, s91, 5
    s_add_u32 s20, s20, s73
    s_mul_i32 s73, s3, 3
    s_add_u32 s20, s20, s73
    s_lshl_b32 s20, s20, 2
    s_lshr_b32 s73, s20, 6
    s_mul_i32 s73, s73, 64
    s_add_u32 s20, s20, s73
    s_add_u32 s20, s20, 16384
    v_mov_b32 v29, 159748
    s_mov_b32 s79, 1280000
swb10:
    ds_read_b32 v30, v29
    s_waitcnt lgkmcnt(0)
    v_cmp_gt_u32 vcc, 4, v30
    s_cbranch_vccz swb10_ok
    s_sleep 1
    s_sub_u32 s79, s79, 1
    s_cbranch_scc0 swb10
swb10_ok:
    ds_read_b128 a[0:3], v6 offset:0
    ds_read_b128 a[4:7], v6 offset:1024
    ds_read_b128 a[8:11], v6 offset:2048
    ds_read_b128 a[12:15], v6 offset:3072
    ds_read_b128 a[16:19], v6 offset:4096
    ds_read_b128 a[20:23], v6 offset:5120
    ds_read_b128 a[24:27], v6 offset:6144
    ds_read_b128 a[28:31], v6 offset:7168
    s_waitcnt lgkmcnt(6)
    v_mfma_f32_16x16x32_bf16 v[72:75], v[130:133], a[0:3], 0
    v_mfma_f32_16x16x32_bf16 v[64:67], v[128:131], a[0:3], 0
    v_mfma_f32_16x16x32_bf16 v[76:79], v[130:133], a[4:7], 0
    v_mfma_f32_16x16x32_bf16 v[68:71], v[128:131], a[4:7], 0
    s_waitcnt lgkmcnt(4)
    v_mfma_f32_16x16x32_bf16 v[72:75], v[136:139], a[8:11], v[72:75]
    v_mfma_f32_16x16x32_bf16 v[64:67], v[134:137], a[8:11], v[64:67]
    v_mfma_f32_16x16x32_bf16 v[76:79], v[136:139], a[12:15], v[76:79]
    v_mfma_f32_16x16x32_bf16 v[68:71], v[134:137], a[12:15], v[68:71]
    s_waitcnt lgkmcnt(2)
    v_mfma_f32_16x16x32_bf16 v[72:75], v[142:145], a[16:19], v[72:75]
    v_mfma_f32_16x16x32_bf16 v[64:67], v[140:143], a[16:19], v[64:67]
    v_mfma_f32_16x16x32_bf16 v[76:79], v[142:145], a[20:23], v[76:79]
    v_mfma_f32_16x16x32_bf16 v[68:71], v[140:143], a[20:23], v[68:71]
    s_waitcnt lgkmcnt(0)
    v_mfma_f32_16x16x32_bf16 v[72:75], v[148:151], a[24:27], v[72:75]
    v_mfma_f32_16x16x32_bf16 v[64:67], v[146:149], a[24:27], v[64:67]
    v_mfma_f32_16x16x32_bf16 v[76:79], v[148:151], a[28:31], v[76:79]
    v_mfma_f32_16x16x32_bf16 v[68:71], v[146:149], a[28:31], v[68:71]
    s_add_u32 s74, s74, 6291456
    s_lshl_b32 s75, s64, 8
    s_add_u32 s75, s75, s78
    s_mul_i32 s75, s75, 16
    s_lshr_b32 s73, s75, 7
    s_mul_i32 s73, s73, 0
    s_add_u32 s75, s75, s73
    s_add_u32 s75, s75, 32768
    s_mul_i32 s84, s91, 57
    s_mul_i32 s73, s23, 28
    s_add_u32 s84, s84, s73
    s_mul_i32 s73, s3, 14
    s_add_u32 s84, s84, s73
    s_lshl_b32 s84, s84, 10
    s_add_u32 s84, s84, 8388608
    v_pk_mul_f32 v[64:65], v[64:65], v[96:97]
    v_pk_mul_f32 v[72:73], v[72:73], v[96:97]
    v_pk_mul_f32 v[66:67], v[66:67], v[98:99]
    v_pk_mul_f32 v[74:75], v[74:75], v[98:99]
    v_pk_mul_f32 v[68:69], v[68:69], v[100:101]
    v_pk_mul_f32 v[76:77], v[76:77], v[100:101]
    v_pk_mul_f32 v[70:71], v[70:71], v[102:103]
    v_pk_mul_f32 v[78:79], v[78:79], v[102:103]
    v_cvt_pk_bf16_f32 v80, v64, v72
    v_cvt_pk_bf16_f32 v81, v65, v73
    v_cvt_pk_bf16_f32 v82, v66, v74
    v_cvt_pk_bf16_f32 v83, v67, v75
    buffer_store_dwordx4 v[80:83], v7, s[48:51], s74 offen offset:0 sc1
    v_cvt_pk_bf16_f32 v84, v68, v76
    v_cvt_pk_bf16_f32 v85, v69, v77
    v_cvt_pk_bf16_f32 v86, v70, v78
    v_cvt_pk_bf16_f32 v87, v71, v79
    buffer_store_dwordx4 v[84:87], v7, s[48:51], s74 offen offset:1024 sc1
    s_cmp_lg_u32 s85, 0
    s_cbranch_scc1 L_ts11
    s_waitcnt vmcnt(2)
    v_mov_b32 v26, s71
    s_mov_b64 exec, 1
    buffer_store_dword v26, v7, s[48:51], s77 offen sc1
    s_mov_b64 exec, -1
    s_mov_b32 s85, 1
L_ts11:
    s_mov_b32 s77, s75
    s_cmp_ge_u32 s65, 4
    s_cbranch_scc0 L_p3
    s_waitcnt vmcnt(0)
    v_mov_b32 v26, s71
    s_mov_b64 exec, 1
    buffer_store_dword v26, v7, s[48:51], s77 offen sc1
    s_mov_b64 exec, -1
    s_branch L_fin
L_p3:
    v_mov_b32 v29, 159780
    v_mov_b32 v30, 1
    s_mov_b64 exec, 1
    ds_add_u32 v29, v30
    s_mov_b64 exec, -1
    s_mov_b32 s85, 0
    s_add_u32 s98, s20, 128
    s_load_dwordx4 s[4:7], s[24:25], s20 glc
    s_load_dwordx4 s[8:11], s[24:25], s98 glc
    s_lshl_b32 s73, s86, 6
    s_lshl_b32 s72, s64, 3
    s_add_u32 s72, s72, s73
    v_lshrrev_b32 v13, 3, v1
    v_add_u32 v13, s72, v13
    v_lshlrev_b32 v15, 2, v13
    v_bfe_u32 v12, v13, 2, 4
    v_bfe_u32 v14, v13, 8, 1
    v_lshl_add_u32 v12, v14, 4, v12
    v_and_b32 v14, 3, v13
    v_lshl_add_u32 v12, v14, 5, v12
    v_and_b32 v14, 0xc0, v13
    v_lshl_add_u32 v12, v14, 1, v12
    v_and_b32 v14, 0x600, v13
    v_add_u32 v12, v12, v14
    v_mul_u32_u24 v12, 896, v12
    v_and_b32 v14, 7, v1
    v_lshl_add_u32 v12, v14, 4, v12
    v_and_b32 v13, 31, v13
    v_and_b32 v17, 3, v1
    v_lshlrev_b32 v17, 2, v17
    v_xor_b32 v16, v13, v17
    v_lshlrev_b32 v16, 4, v16
    v_lshl_add_u32 v16, v14, 10, v16
    s_lshl_b32 s72, s81, 13
    v_add_u32 v16, s72, v16
    v_and_b32 v22, 0xfff, v16
    v_bfe_u32 v14, v1, 2, 1
    v_mul_u32_u24 v14, 14336, v14
    s_lshl_b32 s72, s81, 12
    v_add3_u32 v22, v22, v14, s72
    s_mov_b32 s73, 65536
    buffer_load_dword v15, v15, s[48:51], s73 offen sc1
    s_waitcnt lgkmcnt(0)
    s_xor_b64 s[8:9], s[8:9], s[92:93]
    s_xor_b64 s[10:11], s[10:11], s[92:93]
    s_or_b64 s[8:9], s[8:9], s[10:11]
    s_cselect_b32 s78, 0, 1
    s_mov_b32 s79, 20000
sp13:
    s_cmp_lg_u32 s85, 0
    s_cbranch_scc1 L_ts14
    s_getreg_b32 s72, hwreg(HW_REG_IB_STS)
    s_and_b32 s72, s72, 0xc000000f
    s_cmp_gt_u32 s72, 0
    s_cbranch_scc1 L_ts14
    s_waitcnt vmcnt(0)
    v_mov_b32 v26, s71
    s_mov_b64 exec, 1
    buffer_store_dword v26, v7, s[48:51], s77 offen sc1
    s_mov_b64 exec, -1
    s_mov_b32 s85, 1
L_ts14:
    s_waitcnt lgkmcnt(0)
    s_or_b64 s[98:99], s[4:5], s[6:7]
    s_and_b64 s[4:5], s[4:5], s[6:7]
    s_xor_b64 s[98:99], s[98:99], s[92:93]
    s_xor_b64 s[4:5], s[4:5], s[92:93]
    s_or_b64 s[4:5], s[4:5], s[98:99]
    s_cbranch_scc0 sp13_ok
    s_sleep 2
    s_load_dwordx4 s[4:7], s[24:25], s20 glc
    s_sub_u32 s79, s79, 1
    s_cbranch_scc0 sp13
    s_waitcnt lgkmcnt(0)
sp13_ok:
    s_cmp_lg_u32 s85, 0
    s_cbranch_scc1 L_ts15
    s_waitcnt vmcnt(0)
    v_mov_b32 v26, s71
    s_mov_b64 exec, 1
    buffer_store_dword v26, v7, s[48:51], s77 offen sc1
    s_mov_b64 exec, -1
    s_mov_b32 s85, 1
L_ts15:
    buffer_load_dwordx4 a[0:3], v7, s[48:51], s84 offen offset:0 sc1
    buffer_load_dwordx4 a[4:7], v7, s[48:51], s84 offen offset:1024 sc1
    buffer_load_dwordx4 a[8:11], v7, s[48:51], s84 offen offset:2048 sc1
    buffer_load_dwordx4 a[12:15], v7, s[48:51], s84 offen offset:3072 sc1
    s_add_u32 s84, s84, 4096
    buffer_load_dwordx4 a[16:19], v7, s[48:51], s84 offen offset:0 sc1
    buffer_load_dwordx4 a[20:23], v7, s[48:51], s84 offen offset:1024 sc1
    s_add_u32 s20, s20, 128
    v_mov_b32 v29, 159760
    s_mov_b32 s79, 1280000
swb16:
    s_cmp_lg_u32 s85, 0
    s_cbranch_scc1 L_ts17
    s_getreg_b32 s72, hwreg(HW_REG_IB_STS)
    s_and_b32 s72, s72, 0xc000000f
    s_cmp_gt_u32 s72, 6
    s_cbranch_scc1 L_ts17
    s_waitcnt vmcnt(6)
    v_mov_b32 v26, s71
    s_mov_b64 exec, 1
    buffer_store_dword v26, v7, s[48:51], s77 offen sc1
    s_mov_b64 exec, -1
    s_mov_b32 s85, 1
L_ts17:
    ds_read_b32 v30, v29
    s_waitcnt lgkmcnt(0)
    v_cmp_gt_u32 vcc, 4, v30
    s_cbranch_vccz swb16_ok
    s_sleep 1
    s_sub_u32 s79, s79, 1
    s_cbranch_scc0 swb16
swb16_ok:
    ds_read_b64_tr_b16 v[96:97], v18 offset:0
    ds_read_b64_tr_b16 v[98:99], v18 offset:1024
    ds_read_b64_tr_b16 v[100:101], v19 offset:0
    ds_read_b64_tr_b16 v[102:103], v19 offset:1024
    ds_read_b64_tr_b16 v[104:105], v18 offset:2048
    ds_read_b64_tr_b16 v[106:107], v18 offset:3072
    ds_read_b64_tr_b16 v[108:109], v19 offset:2048
    ds_read_b64_tr_b16 v[110:111], v19 offset:3072
    s_cmp_lg_u32 s85, 0
    s_cbranch_scc1 L_ts18
    s_waitcnt vmcnt(6)
    v_mov_b32 v26, s71
    s_mov_b64 exec, 1
    buffer_store_dword v26, v7, s[48:51], s77 offen sc1
    s_mov_b64 exec, -1
    s_mov_b32 s85, 1
L_ts18:
    s_waitcnt vmcnt(5) lgkmcnt(6)
    v_mfma_f32_32x32x16_bf16 v[64:79], v[96:99], a[0:3], 0
    ds_read_b64_tr_b16 v[112:113], v18 offset:4096
    ds_read_b64_tr_b16 v[114:115], v18 offset:5120
    s_waitcnt lgkmcnt(6)
    v_mfma_f32_32x32x16_bf16 v[80:95], v[100:103], a[0:3], 0
    ds_read_b64_tr_b16 v[116:117], v19 offset:4096
    ds_read_b64_tr_b16 v[118:119], v19 offset:5120
    buffer_load_dwordx4 a[24:27], v7, s[48:51], s84 offen offset:2048 sc1
    s_waitcnt vmcnt(5) lgkmcnt(6)
    v_mfma_f32_32x32x16_bf16 v[64:79], v[104:107], a[4:7], v[64:79]
    ds_read_b64_tr_b16 v[96:97], v18 offset:6144
    ds_read_b64_tr_b16 v[98:99], v18 offset:7168
    s_waitcnt lgkmcnt(6)
    v_mfma_f32_32x32x16_bf16 v[80:95], v[108:111], a[4:7], v[80:95]
    ds_read_b64_tr_b16 v[100:101], v19 offset:6144
    ds_read_b64_tr_b16 v[102:103], v19 offset:7168
    buffer_load_dwordx4 a[28:31], v7, s[48:51], s84 offen offset:3072 sc1
    s_add_u32 s84, s84, 4096
    s_cmp_lg_u32 s78, 0
    s_cbranch_scc1 L_nb19
    s_load_dwordx4 s[4:7], s[24:25], s20 glc
L_nb19:
    s_waitcnt vmcnt(5) lgkmcnt(6)
    v_mfma_f32_32x32x16_bf16 v[64:79], v[112:115], a[8:11], v[64:79]
    ds_read_b64_tr_b16 v[104:105], v18 offset:8192
    ds_read_b64_tr_b16 v[106:107], v18 offset:9216
    s_waitcnt lgkmcnt(6)
    v_mfma_f32_32x32x16_bf16 v[80:95], v[116:119], a[8:11], v[80:95]
    ds_read_b64_tr_b16 v[108:109], v19 offset:8192
    ds_read_b64_tr_b16 v[110:111], v19 offset:9216
    buffer_load_dwordx4 a[32:35], v7, s[48:51], s84 offen offset:0 sc1
    s_waitcnt vmcnt(5) lgkmcnt(6)
    v_mfma_f32_32x32x16_bf16 v[64:79], v[96:99], a[12:15], v[64:79]
    ds_read_b64_tr_b16 v[112:113], v18 offset:10240
    ds_read_b64_tr_b16 v[114:115], v18 offset:11264
    s_waitcnt lgkmcnt(6)
    v_mfma_f32_32x32x16_bf16 v[80:95], v[100:103], a[12:15], v[80:95]
    ds_read_b64_tr_b16 v[116:117], v19 offset:10240
    ds_read_b64_tr_b16 v[118:119], v19 offset:11264
    buffer_load_dwordx4 a[36:39], v7, s[48:51], s84 offen offset:1024 sc1
    s_waitcnt vmcnt(5) lgkmcnt(6)
    v_mfma_f32_32x32x16_bf16 v[64:79], v[104:107], a[16:19], v[64:79]
    ds_read_b64_tr_b16 v[96:97], v18 offset:12288
    ds_read_b64_tr_b16 v[98:99], v18 offset:13312
    s_waitcnt lgkmcnt(6)
    v_mfma_f32_32x32x16_bf16 v[80:95], v[108:111], a[16:19], v[80:95]
    ds_read_b64_tr_b16 v[100:101], v19 offset:12288
    ds_read_b64_tr_b16 v[102:103], v19 offset:13312
    buffer_load_dwordx4 a[40:43], v7, s[48:51], s84 offen offset:2048 sc1
    s_waitcnt vmcnt(5) lgkmcnt(6)
    v_mfma_f32_32x32x16_bf16 v[64:79], v[112:115], a[20:23], v[64:79]
    ds_read_b64_tr_b16 v[104:105], v18 offset:14336
    ds_read_b64_tr_b16 v[106:107], v18 offset:15360
    s_waitcnt lgkmcnt(6)
    v_mfma_f32_32x32x16_bf16 v[80:95], v[116:119], a[20:23], v[80:95]
    ds_read_b64_tr_b16 v[108:109], v19 offset:14336
    ds_read_b64_tr_b16 v[110:111], v19 offset:15360
    buffer_load_dwordx4 a[44:47], v7, s[48:51], s84 offen offset:3072 sc1
    s_add_u32 s84, s84, 4096
    s_waitcnt vmcnt(5) lgkmcnt(6)
    v_mfma_f32_32x32x16_bf16 v[64:79], v[96:99], a[24:27], v[64:79]
    ds_read_b64_tr_b16 v[112:113], v18 offset:16384
    ds_read_b64_tr_b16 v[114:115], v18 offset:17408
    s_waitcnt lgkmcnt(6)
    v_mfma_f32_32x32x16_bf16 v[80:95], v[100:103], a[24:27], v[80:95]
    ds_read_b64_tr_b16 v[116:117], v19 offset:16384
    ds_read_b64_tr_b16 v[118:119], v19 offset:17408
    buffer_load_dwordx4 a[48:51], v7, s[48:51], s84 offen offset:0 sc1
    s_waitcnt vmcnt(5) lgkmcnt(6)
    v_mfma_f32_32x32x16_bf16 v[64:79], v[104:107], a[28:31], v[64:79]
    ds_read_b64_tr_b16 v[96:97], v18 offset:18432
    ds_read_b64_tr_b16 v[98:99], v18 offset:19456
    s_waitcnt lgkmcnt(6)
    v_mfma_f32_32x32x16_bf16 v[80:95], v[108:111], a[28:31], v[80:95]
    ds_read_b64_tr_b16 v[100:101], v19 offset:18432
    ds_read_b64_tr_b16 v[102:103], v19 offset:19456
    buffer_load_dwordx4 a[52:55], v7, s[48:51], s84 offen offset:1024 sc1
    s_add_u32 s84, s84, 3723264
    s_cmp_lg_u32 s78, 0
    s_cbranch_scc1 L_nb20
    s_mov_b32 s79, 20000
sp21:
    s_waitcnt lgkmcnt(0)
    s_or_b64 s[98:99], s[4:5], s[6:7]
    s_and_b64 s[4:5], s[4:5], s[6:7]
    s_xor_b64 s[98:99], s[98:99], s[92:93]
    s_xor_b64 s[4:5], s[4:5], s[92:93]
    s_or_b64 s[4:5], s[4:5], s[98:99]
    s_cbranch_scc0 sp21_ok
    s_sleep 2
    s_load_dwordx4 s[4:7], s[24:25], s20 glc
    s_sub_u32 s79, s79, 1
    s_cbranch_scc0 sp21
    s_waitcnt lgkmcnt(0)
sp21_ok:
L_nb20:
    s_waitcnt vmcnt(5) lgkmcnt(6)
    v_mfma_f32_32x32x16_bf16 v[64:79], v[112:115], a[32:35], v[64:79]
    ds_read_b64_tr_b16 v[104:105], v18 offset:20480
    ds_read_b64_tr_b16 v[106:107], v18 offset:21504
    s_waitcnt lgkmcnt(6)
    v_mfma_f32_32x32x16_bf16 v[80:95], v[116:119], a[32:35], v[80:95]
    ds_read_b64_tr_b16 v[108:109], v19 offset:20480
    ds_read_b64_tr_b16 v[110:111], v19 offset:21504
    buffer_load_dwordx4 a[56:59], v7, s[48:51], s84 offen offset:0 sc1
    s_waitcnt vmcnt(5) lgkmcnt(6)
    v_mfma_f32_32x32x16_bf16 v[64:79], v[96:99], a[36:39], v[64:79]
    ds_read_b64_tr_b16 v[112:113], v18 offset:22528
    ds_read_b64_tr_b16 v[114:115], v18 offset:23552
    s_waitcnt lgkmcnt(6)
    v_mfma_f32_32x32x16_bf16 v[80:95], v[100:103], a[36:39], v[80:95]
    ds_read_b64_tr_b16 v[116:117], v19 offset:22528
    ds_read_b64_tr_b16 v[118:119], v19 offset:23552
    buffer_load_dwordx4 a[60:63], v7, s[48:51], s84 offen offset:1024 sc1
    s_waitcnt vmcnt(5) lgkmcnt(6)
    v_mfma_f32_32x32x16_bf16 v[64:79], v[104:107], a[40:43], v[64:79]
    ds_read_b64_tr_b16 v[96:97], v18 offset:24576
    ds_read_b64_tr_b16 v[98:99], v18 offset:25600
    s_waitcnt lgkmcnt(6)
    v_mfma_f32_32x32x16_bf16 v[80:95], v[108:111], a[40:43], v[80:95]
    ds_read_b64_tr_b16 v[100:101], v19 offset:24576
    ds_read_b64_tr_b16 v[102:103], v19 offset:25600
    buffer_load_dwordx4 a[0:3], v7, s[48:51], s84 offen offset:2048 sc1
    s_waitcnt vmcnt(5) lgkmcnt(6)
    v_mfma_f32_32x32x16_bf16 v[64:79], v[112:115], a[44:47], v[64:79]
    ds_read_b64_tr_b16 v[104:105], v18 offset:26624
    ds_read_b64_tr_b16 v[106:107], v18 offset:27648
    s_waitcnt lgkmcnt(6)
    v_mfma_f32_32x32x16_bf16 v[80:95], v[116:119], a[44:47], v[80:95]
    ds_read_b64_tr_b16 v[108:109], v19 offset:26624
    ds_read_b64_tr_b16 v[110:111], v19 offset:27648
    buffer_load_dwordx4 a[4:7], v7, s[48:51], s84 offen offset:3072 sc1
    s_add_u32 s84, s84, 4096
    v_mov_b32 v29, 159756
    s_mov_b32 s79, 1280000
swb22:
    ds_read_b32 v30, v29
    s_waitcnt lgkmcnt(0)
    v_cmp_gt_u32 vcc, 4, v30
    s_cbranch_vccz swb22_ok
    s_sleep 1
    s_sub_u32 s79, s79, 1
    s_cbranch_scc0 swb22
swb22_ok:
    s_waitcnt vmcnt(5) lgkmcnt(6)
    v_mfma_f32_32x32x16_bf16 v[64:79], v[96:99], a[48:51], v[64:79]
    v_add_u32 v18, 0x10000, v18
    v_add_u32 v19, 0x10000, v19
    ds_read_b64_tr_b16 v[112:113], v18 offset:0
    ds_read_b64_tr_b16 v[114:115], v18 offset:1024
    s_waitcnt lgkmcnt(6)
    v_mfma_f32_32x32x16_bf16 v[80:95], v[100:103], a[48:51], v[80:95]
    ds_read_b64_tr_b16 v[116:117], v19 offset:0
    ds_read_b64_tr_b16 v[118:119], v19 offset:1024
    buffer_load_dwordx4 a[8:11], v7, s[48:51], s84 offen offset:0 sc1
    s_waitcnt vmcnt(5) lgkmcnt(6)
    v_mfma_f32_32x32x16_bf16 v[64:79], v[104:107], a[52:55], v[64:79]
    ds_read_b64_tr_b16 v[96:97], v18 offset:2048
    ds_read_b64_tr_b16 v[98:99], v18 offset:3072
    s_waitcnt lgkmcnt(6)
    v_mfma_f32_32x32x16_bf16 v[80:95], v[108:111], a[52:55], v[80:95]
    ds_read_b64_tr_b16 v[100:101], v19 offset:2048
    ds_read_b64_tr_b16 v[102:103], v19 offset:3072
    buffer_load_dwordx4 a[12:15], v7, s[48:51], s84 offen offset:1024 sc1
    v_mov_b32 v29, 159776
    v_mov_b32 v30, 1
    s_mov_b64 exec, 1
    ds_add_u32 v29, v30
    s_mov_b64 exec, -1
    s_waitcnt vmcnt(5) lgkmcnt(7)
    v_mfma_f32_32x32x16_bf16 v[64:79], v[112:115], a[56:59], v[64:79]
    ds_read_b64_tr_b16 v[104:105], v18 offset:4096
    ds_read_b64_tr_b16 v[106:107], v18 offset:5120
    s_waitcnt lgkmcnt(7)
    v_mfma_f32_32x32x16_bf16 v[80:95], v[116:119], a[56:59], v[80:95]
    ds_read_b64_tr_b16 v[108:109], v19 offset:4096
    ds_read_b64_tr_b16 v[110:111], v19 offset:5120
    buffer_load_dwordx4 a[16:19], v7, s[48:51], s84 offen offset:2048 sc1
    s_waitcnt vmcnt(5) lgkmcnt(7)
    v_mfma_f32_32x32x16_bf16 v[64:79], v[96:99], a[60:63], v[64:79]
    ds_read_b64_tr_b16 v[112:113], v18 offset:6144
    ds_read_b64_tr_b16 v[114:115], v18 offset:7168
    s_waitcnt lgkmcnt(7)
    v_mfma_f32_32x32x16_bf16 v[80:95], v[100:103], a[60:63], v[80:95]
    ds_read_b64_tr_b16 v[116:117], v19 offset:6144
    ds_read_b64_tr_b16 v[118:119], v19 offset:7168
    buffer_load_dwordx4 a[20:23], v7, s[48:51], s84 offen offset:3072 sc1
    s_add_u32 s84, s84, 4096
    s_waitcnt vmcnt(5) lgkmcnt(6)
    v_mfma_f32_32x32x16_bf16 v[64:79], v[104:107], a[0:3], v[64:79]
    ds_read_b64_tr_b16 v[96:97], v18 offset:8192
    ds_read_b64_tr_b16 v[98:99], v18 offset:9216
    s_waitcnt lgkmcnt(6)
    v_mfma_f32_32x32x16_bf16 v[80:95], v[108:111], a[0:3], v[80:95]
    ds_read_b64_tr_b16 v[100:101], v19 offset:8192
    ds_read_b64_tr_b16 v[102:103], v19 offset:9216
    buffer_load_dwordx4 a[24:27], v7, s[48:51], s84 offen offset:0 sc1
    s_waitcnt vmcnt(5) lgkmcnt(6)
    v_mfma_f32_32x32x16_bf16 v[64:79], v[112:115], a[4:7], v[64:79]
    ds_read_b64_tr_b16 v[104:105], v18 offset:10240
    ds_read_b64_tr_b16 v[106:107], v18 offset:11264
    s_waitcnt lgkmcnt(6)
    v_mfma_f32_32x32x16_bf16 v[80:95], v[116:119], a[4:7], v[80:95]
    ds_read_b64_tr_b16 v[108:109], v19 offset:10240
    ds_read_b64_tr_b16 v[110:111], v19 offset:11264
    buffer_load_dwordx4 a[28:31], v7, s[48:51], s84 offen offset:1024 sc1
    s_waitcnt vmcnt(5) lgkmcnt(6)
    v_mfma_f32_32x32x16_bf16 v[64:79], v[96:99], a[8:11], v[64:79]
    ds_read_b64_tr_b16 v[112:113], v18 offset:12288
    ds_read_b64_tr_b16 v[114:115], v18 offset:13312
    s_waitcnt lgkmcnt(6)
    v_mfma_f32_32x32x16_bf16 v[80:95], v[100:103], a[8:11], v[80:95]
    ds_read_b64_tr_b16 v[116:117], v19 offset:12288
    ds_read_b64_tr_b16 v[118:119], v19 offset:13312
    buffer_load_dwordx4 a[32:35], v7, s[48:51], s84 offen offset:2048 sc1
    s_waitcnt vmcnt(5) lgkmcnt(6)
    v_mfma_f32_32x32x16_bf16 v[64:79], v[104:107], a[12:15], v[64:79]
    ds_read_b64_tr_b16 v[96:97], v18 offset:14336
    ds_read_b64_tr_b16 v[98:99], v18 offset:15360
    s_waitcnt lgkmcnt(6)
    v_mfma_f32_32x32x16_bf16 v[80:95], v[108:111], a[12:15], v[80:95]
    ds_read_b64_tr_b16 v[100:101], v19 offset:14336
    ds_read_b64_tr_b16 v[102:103], v19 offset:15360
    buffer_load_dwordx4 a[36:39], v7, s[48:51], s84 offen offset:3072 sc1
    s_add_u32 s84, s84, 4096
    s_waitcnt vmcnt(5) lgkmcnt(6)
    v_mfma_f32_32x32x16_bf16 v[64:79], v[112:115], a[16:19], v[64:79]
    ds_read_b64_tr_b16 v[104:105], v18 offset:16384
    ds_read_b64_tr_b16 v[106:107], v18 offset:17408
    s_waitcnt lgkmcnt(6)
    v_mfma_f32_32x32x16_bf16 v[80:95], v[116:119], a[16:19], v[80:95]
    ds_read_b64_tr_b16 v[108:109], v19 offset:16384
    ds_read_b64_tr_b16 v[110:111], v19 offset:17408
    buffer_load_dwordx4 a[40:43], v7, s[48:51], s84 offen offset:0 sc1
    s_waitcnt vmcnt(5) lgkmcnt(6)
    v_mfma_f32_32x32x16_bf16 v[64:79], v[96:99], a[20:23], v[64:79]
    ds_read_b64_tr_b16 v[112:113], v18 offset:18432
    ds_read_b64_tr_b16 v[114:115], v18 offset:19456
    s_waitcnt lgkmcnt(6)
    v_mfma_f32_32x32x16_bf16 v[80:95], v[100:103], a[20:23], v[80:95]
    ds_read_b64_tr_b16 v[116:117], v19 offset:18432
    ds_read_b64_tr_b16 v[118:119], v19 offset:19456
    buffer_load_dwordx4 a[44:47], v7, s[48:51], s84 offen offset:1024 sc1
    s_add_u32 s84, s84, 3723264
    s_waitcnt vmcnt(5) lgkmcnt(6)
    v_mfma_f32_32x32x16_bf16 v[64:79], v[104:107], a[24:27], v[64:79]
    ds_read_b64_tr_b16 v[96:97], v18 offset:20480
    ds_read_b64_tr_b16 v[98:99], v18 offset:21504
    s_waitcnt lgkmcnt(6)
    v_mfma_f32_32x32x16_bf16 v[80:95], v[108:111], a[24:27], v[80:95]
    ds_read_b64_tr_b16 v[100:101], v19 offset:20480
    ds_read_b64_tr_b16 v[102:103], v19 offset:21504
    s_waitcnt vmcnt(4) lgkmcnt(6)
    v_mfma_f32_32x32x16_bf16 v[64:79], v[112:115], a[28:31], v[64:79]
    ds_read_b64_tr_b16 v[104:105], v18 offset:22528
    ds_read_b64_tr_b16 v[106:107], v18 offset:23552
    s_waitcnt lgkmcnt(6)
    v_mfma_f32_32x32x16_bf16 v[80:95], v[116:119], a[28:31], v[80:95]
    ds_read_b64_tr_b16 v[108:109], v19 offset:22528
    ds_read_b64_tr_b16 v[110:111], v19 offset:23552
    s_waitcnt vmcnt(3) lgkmcnt(6)
    v_mfma_f32_32x32x16_bf16 v[64:79], v[96:99], a[32:35], v[64:79]
    ds_read_b64_tr_b16 v[112:113], v18 offset:24576
    ds_read_b64_tr_b16 v[114:115], v18 offset:25600
    s_waitcnt lgkmcnt(6)
    v_mfma_f32_32x32x16_bf16 v[80:95], v[100:103], a[32:35], v[80:95]
    ds_read_b64_tr_b16 v[116:117], v19 offset:24576
    ds_read_b64_tr_b16 v[118:119], v19 offset:25600
    s_waitcnt vmcnt(2) lgkmcnt(6)
    v_mfma_f32_32x32x16_bf16 v[64:79], v[104:107], a[36:39], v[64:79]
    ds_read_b64_tr_b16 v[96:97], v18 offset:26624
    ds_read_b64_tr_b16 v[98:99], v18 offset:27648
    s_waitcnt lgkmcnt(6)
    v_mfma_f32_32x32x16_bf16 v[80:95], v[108:111], a[36:39], v[80:95]
    ds_read_b64_tr_b16 v[100:101], v19 offset:26624
    ds_read_b64_tr_b16 v[102:103], v19 offset:27648
    s_waitcnt vmcnt(1) lgkmcnt(6)
    v_mfma_f32_32x32x16_bf16 v[64:79], v[112:115], a[40:43], v[64:79]
    s_waitcnt lgkmcnt(4)
    v_mfma_f32_32x32x16_bf16 v[80:95], v[116:119], a[40:43], v[80:95]
    s_waitcnt vmcnt(0) lgkmcnt(2)
    v_mfma_f32_32x32x16_bf16 v[64:79], v[96:99], a[44:47], v[64:79]
    s_waitcnt lgkmcnt(0)
    v_mfma_f32_32x32x16_bf16 v[80:95], v[100:103], a[44:47], v[80:95]
    s_xor_b32 s20, s2, 1
    s_lshl_b32 s20, s20, 7
    s_lshr_b32 s72, s20, 7
    s_mul_i32 s72, s72, 0
    s_add_u32 s20, s20, s72
    s_add_u32 s20, s20, 81920
    s_lshl_b32 s72, s80, 4
    s_add_u32 s20, s20, s72
    v_mov_b32 v29, 159776
    s_mov_b32 s79, 1280000
swb23:
    ds_read_b32 v30, v29
    s_waitcnt lgkmcnt(0)
    v_cmp_gt_u32 vcc, 8, v30
    s_cbranch_vccz swb23_ok
    s_sleep 1
    s_sub_u32 s79, s79, 1
    s_cbranch_scc0 swb23
swb23_ok:
    s_load_dwordx4 s[4:7], s[24:25], s20 glc
    s_lshl_b32 s72, s64, 13
    s_lshl_b32 s73, s3, 12
    s_add_u32 s72, s72, s73
    v_add_u32 v32, s72, v7
    v_xor_b32 v33, 64, v32
    v_xor_b32 v34, 128, v32
    v_xor_b32 v35, 192, v32
    v_xor_b32 v36, 4096, v32
    v_xor_b32 v37, 4096, v33
    v_xor_b32 v38, 4096, v34
    v_xor_b32 v39, 4096, v35
    s_xor_b32 s73, s2, 1
    s_lshl_b32 s73, s73, 2
    s_add_u32 s73, s73, s80
    s_lshl_b32 s73, s73, 12
    s_add_u32 s73, s73, 16777216
    s_mov_b32 s79, 20000
sp24:
    s_waitcnt lgkmcnt(0)
    s_or_b64 s[98:99], s[4:5], s[6:7]
    s_and_b64 s[4:5], s[4:5], s[6:7]
    s_xor_b64 s[98:99], s[98:99], s[92:93]
    s_xor_b64 s[4:5], s[4:5], s[92:93]
    s_or_b64 s[4:5], s[4:5], s[98:99]
    s_cbranch_scc0 sp24_ok
    s_sleep 2
    s_load_dwordx4 s[4:7], s[24:25], s20 glc
    s_sub_u32 s79, s79, 1
    s_cbranch_scc0 sp24
    s_waitcnt lgkmcnt(0)
sp24_ok:
    buffer_load_dwordx4 v[96:99], v7, s[48:51], s73 offen offset:0 sc1
    buffer_load_dwordx4 v[100:103], v7, s[48:51], s73 offen offset:1024 sc1
    buffer_load_dwordx4 v[104:107], v7, s[48:51], s73 offen offset:2048 sc1
    buffer_load_dwordx4 v[108:111], v7, s[48:51], s73 offen offset:3072 sc1
    s_waitcnt vmcnt(3)
    v_lshlrev_b32 v112, 16, v96
    v_and_b32 v113, 0xffff0000, v96
    v_add_f32 v64, v64, v112
    v_add_f32 v65, v65, v113
    v_lshlrev_b32 v112, 16, v97
    v_and_b32 v113, 0xffff0000, v97
    v_add_f32 v66, v66, v112
    v_add_f32 v67, v67, v113
    v_lshlrev_b32 v112, 16, v98
    v_and_b32 v113, 0xffff0000, v98
    v_add_f32 v68, v68, v112
    v_add_f32 v69, v69, v113
    v_lshlrev_b32 v112, 16, v99
    v_and_b32 v113, 0xffff0000, v99
    v_add_f32 v70, v70, v112
    v_add_f32 v71, v71, v113
    ds_write_b128 v32, v[64:67] offset:0
    ds_write_b128 v33, v[68:71] offset:1024
    s_waitcnt vmcnt(2)
    v_lshlrev_b32 v112, 16, v100
    v_and_b32 v113, 0xffff0000, v100
    v_add_f32 v72, v72, v112
    v_add_f32 v73, v73, v113
    v_lshlrev_b32 v112, 16, v101
    v_and_b32 v113, 0xffff0000, v101
    v_add_f32 v74, v74, v112
    v_add_f32 v75, v75, v113
    v_lshlrev_b32 v112, 16, v102
    v_and_b32 v113, 0xffff0000, v102
    v_add_f32 v76, v76, v112
    v_add_f32 v77, v77, v113
    v_lshlrev_b32 v112, 16, v103
    v_and_b32 v113, 0xffff0000, v103
    v_add_f32 v78, v78, v112
    v_add_f32 v79, v79, v113
    ds_write_b128 v34, v[72:75] offset:2048
    ds_write_b128 v35, v[76:79] offset:3072
    s_waitcnt vmcnt(1)
    v_lshlrev_b32 v112, 16, v104
    v_and_b32 v113, 0xffff0000, v104
    v_add_f32 v80, v80, v112
    v_add_f32 v81, v81, v113
    v_lshlrev_b32 v112, 16, v105
    v_and_b32 v113, 0xffff0000, v105
    v_add_f32 v82, v82, v112
    v_add_f32 v83, v83, v113
    v_lshlrev_b32 v112, 16, v106
    v_and_b32 v113, 0xffff0000, v106
    v_add_f32 v84, v84, v112
    v_add_f32 v85, v85, v113
    v_lshlrev_b32 v112, 16, v107
    v_and_b32 v113, 0xffff0000, v107
    v_add_f32 v86, v86, v112
    v_add_f32 v87, v87, v113
    ds_write_b128 v36, v[80:83] offset:0
    ds_write_b128 v37, v[84:87] offset:1024
    s_waitcnt vmcnt(0)
    v_lshlrev_b32 v112, 16, v108
    v_and_b32 v113, 0xffff0000, v108
    v_add_f32 v88, v88, v112
    v_add_f32 v89, v89, v113
    v_lshlrev_b32 v112, 16, v109
    v_and_b32 v113, 0xffff0000, v109
    v_add_f32 v90, v90, v112
    v_add_f32 v91, v91, v113
    v_lshlrev_b32 v112, 16, v110
    v_and_b32 v113, 0xffff0000, v110
    v_add_f32 v92, v92, v112
    v_add_f32 v93, v93, v113
    v_lshlrev_b32 v112, 16, v111
    v_and_b32 v113, 0xffff0000, v111
    v_add_f32 v94, v94, v112
    v_add_f32 v95, v95, v113
    ds_write_b128 v38, v[88:91] offset:2048
    ds_write_b128 v39, v[92:95] offset:3072
    s_branch L_fin3
L_go3:
    s_waitcnt lgkmcnt(0)
    s_xor_b64 s[8:9], s[8:9], s[92:93]
    s_xor_b64 s[10:11], s[10:11], s[92:93]
    s_or_b64 s[8:9], s[8:9], s[10:11]
    s_cselect_b32 s78, 0, 1
    s_mov_b32 s79, 20000
sp26:
    s_cmp_lg_u32 s85, 0
    s_cbranch_scc1 L_ts27
    s_getreg_b32 s72, hwreg(HW_REG_IB_STS)
    s_and_b32 s72, s72, 0xc000000f
    s_cmp_gt_u32 s72, 0
    s_cbranch_scc1 L_ts27
    s_waitcnt vmcnt(0)
    v_mov_b32 v26, s71
    s_mov_b64 exec, 1
    buffer_store_dword v26, v7, s[48:51], s77 offen sc1
    s_mov_b64 exec, -1
    s_mov_b32 s85, 1
L_ts27:
    s_waitcnt lgkmcnt(0)
    s_or_b64 s[98:99], s[4:5], s[6:7]
    s_and_b64 s[4:5], s[4:5], s[6:7]
    s_xor_b64 s[98:99], s[98:99], s[92:93]
    s_xor_b64 s[4:5], s[4:5], s[92:93]
    s_or_b64 s[4:5], s[4:5], s[98:99]
    s_cbranch_scc0 sp26_ok
    s_sleep 2
    s_load_dwordx4 s[4:7], s[24:25], s20 glc
    s_sub_u32 s79, s79, 1
    s_cbranch_scc0 sp26
    s_waitcnt lgkmcnt(0)
sp26_ok:
    buffer_load_dwordx4 a[0:3], v7, s[48:51], s84 offen offset:0 sc1
    buffer_load_dwordx4 a[4:7], v7, s[48:51], s84 offen offset:1024 sc1
    buffer_load_dwordx4 a[8:11], v7, s[48:51], s84 offen offset:2048 sc1
    buffer_load_dwordx4 a[12:15], v7, s[48:51], s84 offen offset:3072 sc1
    s_add_u32 s84, s84, 4096
    buffer_load_dwordx4 a[16:19], v7, s[48:51], s84 offen offset:0 sc1
    buffer_load_dwordx4 a[20:23], v7, s[48:51], s84 offen offset:1024 sc1
    buffer_load_dwordx4 a[24:27], v7, s[48:51], s84 offen offset:2048 sc1
    buffer_load_dwordx4 a[28:31], v7, s[48:51], s84 offen offset:3072 sc1
    s_add_u32 s84, s84, 4096
    s_add_u32 s20, s20, 128
    v_mov_b32 v29, 159760
    s_mov_b32 s79, 1280000
swb28:
    s_cmp_lg_u32 s85, 0
    s_cbranch_scc1 L_ts29
    s_getreg_b32 s72, hwreg(HW_REG_IB_STS)
    s_and_b32 s72, s72, 0xc000000f
    s_cmp_gt_u32 s72, 8
    s_cbranch_scc1 L_ts29
    s_waitcnt vmcnt(8)
    v_mov_b32 v26, s71
    s_mov_b64 exec, 1
    buffer_store_dword v26, v7, s[48:51], s77 offen sc1
    s_mov_b64 exec, -1
    s_mov_b32 s85, 1
L_ts29:
    ds_read_b32 v30, v29
    s_waitcnt lgkmcnt(0)
    v_cmp_gt_u32 vcc, 4, v30
    s_cbranch_vccz swb28_ok
    s_sleep 1
    s_sub_u32 s79, s79, 1
    s_cbranch_scc0 swb28
swb28_ok:
    ds_read_b64_tr_b16 v[96:97], v18 offset:0
    ds_read_b64_tr_b16 v[98:99], v18 offset:1024
    ds_read_b64_tr_b16 v[100:101], v19 offset:0
    ds_read_b64_tr_b16 v[102:103], v19 offset:1024
    ds_read_b64_tr_b16 v[104:105], v18 offset:2048
    ds_read_b64_tr_b16 v[106:107], v18 offset:3072
    ds_read_b64_tr_b16 v[108:109], v19 offset:2048
    ds_read_b64_tr_b16 v[110:111], v19 offset:3072
    s_cmp_lg_u32 s85, 0
    s_cbranch_scc1 L_ts30
    s_waitcnt vmcnt(8)
    v_mov_b32 v26, s71
    s_mov_b64 exec, 1
    buffer_store_dword v26, v7, s[48:51], s77 offen sc1
    s_mov_b64 exec, -1
    s_mov_b32 s85, 1
L_ts30:
    s_cmp_lg_u32 s78, 0
    s_cbranch_scc1 L_nb31
    s_load_dwordx4 s[4:7], s[24:25], s20 glc
L_nb31:
    s_waitcnt vmcnt(7) lgkmcnt(6)
    v_mfma_f32_32x32x16_bf16 v[64:79], v[96:99], a[0:3], 0
    ds_read_b64_tr_b16 v[112:113], v18 offset:4096
    ds_read_b64_tr_b16 v[114:115], v18 offset:5120
    s_waitcnt lgkmcnt(6)
    v_mfma_f32_32x32x16_bf16 v[80:95], v[100:103], a[0:3], 0
    ds_read_b64_tr_b16 v[116:117], v19 offset:4096
    ds_read_b64_tr_b16 v[118:119], v19 offset:5120
    buffer_load_dwordx4 a[32:35], v7, s[48:51], s84 offen offset:0 sc1
    s_waitcnt vmcnt(7) lgkmcnt(6)
    v_mfma_f32_32x32x16_bf16 v[64:79], v[104:107], a[4:7], v[64:79]
    ds_read_b64_tr_b16 v[96:97], v18 offset:6144
    ds_read_b64_tr_b16 v[98:99], v18 offset:7168
    s_waitcnt lgkmcnt(6)
    v_mfma_f32_32x32x16_bf16 v[80:95], v[108:111], a[4:7], v[80:95]
    ds_read_b64_tr_b16 v[100:101], v19 offset:6144
    ds_read_b64_tr_b16 v[102:103], v19 offset:7168
    buffer_load_dwordx4 a[36:39], v7, s[48:51], s84 offen offset:1024 sc1
    s_waitcnt vmcnt(7) lgkmcnt(6)
    v_mfma_f32_32x32x16_bf16 v[64:79], v[112:115], a[8:11], v[64:79]
    ds_read_b64_tr_b16 v[104:105], v18 offset:8192
    ds_read_b64_tr_b16 v[106:107], v18 offset:9216
    s_waitcnt lgkmcnt(6)
    v_mfma_f32_32x32x16_bf16 v[80:95], v[116:119], a[8:11], v[80:95]
    ds_read_b64_tr_b16 v[108:109], v19 offset:8192
    ds_read_b64_tr_b16 v[110:111], v19 offset:9216
    buffer_load_dwordx4 a[40:43], v7, s[48:51], s84 offen offset:2048 sc1
    s_waitcnt vmcnt(7) lgkmcnt(6)
    v_mfma_f32_32x32x16_bf16 v[64:79], v[96:99], a[12:15], v[64:79]
    ds_read_b64_tr_b16 v[112:113], v18 offset:10240
    ds_read_b64_tr_b16 v[114:115], v18 offset:11264
    s_waitcnt lgkmcnt(6)
    v_mfma_f32_32x32x16_bf16 v[80:95], v[100:103], a[12:15], v[80:95]
    ds_read_b64_tr_b16 v[116:117], v19 offset:10240
    ds_read_b64_tr_b16 v[118:119], v19 offset:11264
    buffer_load_dwordx4 a[44:47], v7, s[48:51], s84 offen offset:3072 sc1
    s_add_u32 s84, s84, 4096
    s_waitcnt vmcnt(7) lgkmcnt(6)
    v_mfma_f32_32x32x16_bf16 v[64:79], v[104:107], a[16:19], v[64:79]
    ds_read_b64_tr_b16 v[96:97], v18 offset:12288
    ds_read_b64_tr_b16 v[98:99], v18 offset:13312
    s_waitcnt lgkmcnt(6)
    v_mfma_f32_32x32x16_bf16 v[80:95], v[108:111], a[16:19], v[80:95]
    ds_read_b64_tr_b16 v[100:101], v19 offset:12288
    ds_read_b64_tr_b16 v[102:103], v19 offset:13312
    buffer_load_dwordx4 a[48:51], v7, s[48:51], s84 offen offset:0 sc1
    s_waitcnt vmcnt(7) lgkmcnt(6)
    v_mfma_f32_32x32x16_bf16 v[64:79], v[112:115], a[20:23], v[64:79]
    ds_read_b64_tr_b16 v[104:105], v18 offset:14336
    ds_read_b64_tr_b16 v[106:107], v18 offset:15360
    s_waitcnt lgkmcnt(6)
    v_mfma_f32_32x32x16_bf16 v[80:95], v[116:119], a[20:23], v[80:95]
    ds_read_b64_tr_b16 v[108:109], v19 offset:14336
    ds_read_b64_tr_b16 v[110:111], v19 offset:15360
    buffer_load_dwordx4 a[52:55], v7, s[48:51], s84 offen offset:1024 sc1
    s_add_u32 s84, s84, 3723264
    s_cmp_lg_u32 s78, 0
    s_cbranch_scc1 L_nb32
    s_mov_b32 s79, 20000
sp33:
    s_waitcnt lgkmcnt(0)
    s_or_b64 s[98:99], s[4:5], s[6:7]
    s_and_b64 s[4:5], s[4:5], s[6:7]
    s_xor_b64 s[98:99], s[98:99], s[92:93]
    s_xor_b64 s[4:5], s[4:5], s[92:93]
    s_or_b64 s[4:5], s[4:5], s[98:99]
    s_cbranch_scc0 sp33_ok
    s_sleep 2
    s_load_dwordx4 s[4:7], s[24:25], s20 glc
    s_sub_u32 s79, s79, 1
    s_cbranch_scc0 sp33
    s_waitcnt lgkmcnt(0)
sp33_ok:
L_nb32:
    s_waitcnt vmcnt(7) lgkmcnt(6)
    v_mfma_f32_32x32x16_bf16 v[64:79], v[96:99], a[24:27], v[64:79]
    ds_read_b64_tr_b16 v[112:113], v18 offset:16384
    ds_read_b64_tr_b16 v[114:115], v18 offset:17408
    s_waitcnt lgkmcnt(6)
    v_mfma_f32_32x32x16_bf16 v[80:95], v[100:103], a[24:27], v[80:95]
    ds_read_b64_tr_b16 v[116:117], v19 offset:16384
    ds_read_b64_tr_b16 v[118:119], v19 offset:17408
    buffer_load_dwordx4 a[56:59], v7, s[48:51], s84 offen offset:0 sc1
    s_waitcnt vmcnt(7) lgkmcnt(6)
    v_mfma_f32_32x32x16_bf16 v[64:79], v[104:107], a[28:31], v[64:79]
    ds_read_b64_tr_b16 v[96:97], v18 offset:18432
    ds_read_b64_tr_b16 v[98:99], v18 offset:19456
    s_waitcnt lgkmcnt(6)
    v_mfma_f32_32x32x16_bf16 v[80:95], v[108:111], a[28:31], v[80:95]
    ds_read_b64_tr_b16 v[100:101], v19 offset:18432
    ds_read_b64_tr_b16 v[102:103], v19 offset:19456
    buffer_load_dwordx4 a[60:63], v7, s[48:51], s84 offen offset:1024 sc1
    s_waitcnt vmcnt(7) lgkmcnt(6)
    v_mfma_f32_32x32x16_bf16 v[64:79], v[112:115], a[32:35], v[64:79]
    ds_read_b64_tr_b16 v[104:105], v18 offset:20480
    ds_read_b64_tr_b16 v[106:107], v18 offset:21504
    s_waitcnt lgkmcnt(6)
    v_mfma_f32_32x32x16_bf16 v[80:95], v[116:119], a[32:35], v[80:95]
    ds_read_b64_tr_b16 v[108:109], v19 offset:20480
    ds_read_b64_tr_b16 v[110:111], v19 offset:21504
    buffer_load_dwordx4 a[0:3], v7, s[48:51], s84 offen offset:2048 sc1
    v_mov_b32 v29, 159756
    v_mov_b32 v30, 1
    s_mov_b64 exec, 1
    ds_add_u32 v29, v30
    s_mov_b64 exec, -1
    s_waitcnt vmcnt(7) lgkmcnt(7)
    v_mfma_f32_32x32x16_bf16 v[64:79], v[96:99], a[36:39], v[64:79]
    ds_read_b64_tr_b16 v[112:113], v18 offset:22528
    ds_read_b64_tr_b16 v[114:115], v18 offset:23552
    s_waitcnt lgkmcnt(7)
    v_mfma_f32_32x32x16_bf16 v[80:95], v[100:103], a[36:39], v[80:95]
    ds_read_b64_tr_b16 v[116:117], v19 offset:22528
    ds_read_b64_tr_b16 v[118:119], v19 offset:23552
    buffer_load_dwordx4 a[4:7], v7, s[48:51], s84 offen offset:3072 sc1
    s_add_u32 s84, s84, 4096
    s_waitcnt vmcnt(7) lgkmcnt(7)
    v_mfma_f32_32x32x16_bf16 v[64:79], v[104:107], a[40:43], v[64:79]
    ds_read_b64_tr_b16 v[96:97], v18 offset:24576
    ds_read_b64_tr_b16 v[98:99], v18 offset:25600
    s_waitcnt lgkmcnt(7)
    v_mfma_f32_32x32x16_bf16 v[80:95], v[108:111], a[40:43], v[80:95]
    ds_read_b64_tr_b16 v[100:101], v19 offset:24576
    ds_read_b64_tr_b16 v[102:103], v19 offset:25600
    buffer_load_dwordx4 a[8:11], v7, s[48:51], s84 offen offset:0 sc1
    s_waitcnt vmcnt(7) lgkmcnt(6)
    v_mfma_f32_32x32x16_bf16 v[64:79], v[112:115], a[44:47], v[64:79]
    ds_read_b64_tr_b16 v[104:105], v18 offset:26624
    ds_read_b64_tr_b16 v[106:107], v18 offset:27648
    s_waitcnt lgkmcnt(6)
    v_mfma_f32_32x32x16_bf16 v[80:95], v[116:119], a[44:47], v[80:95]
    ds_read_b64_tr_b16 v[108:109], v19 offset:26624
    ds_read_b64_tr_b16 v[110:111], v19 offset:27648
    buffer_load_dwordx4 a[12:15], v7, s[48:51], s84 offen offset:1024 sc1
    v_mov_b32 v29, 159756
    s_mov_b32 s79, 1280000
swb34:
    ds_read_b32 v30, v29
    s_waitcnt lgkmcnt(0)
    v_cmp_gt_u32 vcc, 4, v30
    s_cbranch_vccz swb34_ok
    s_sleep 1
    s_sub_u32 s79, s79, 1
    s_cbranch_scc0 swb34
swb34_ok:
    s_waitcnt vmcnt(7) lgkmcnt(6)
    v_mfma_f32_32x32x16_bf16 v[64:79], v[96:99], a[48:51], v[64:79]
    v_add_u32 v18, 0x10000, v18
    v_add_u32 v19, 0x10000, v19
    ds_read_b64_tr_b16 v[112:113], v18 offset:0
    ds_read_b64_tr_b16 v[114:115], v18 offset:1024
    s_waitcnt lgkmcnt(6)
    v_mfma_f32_32x32x16_bf16 v[80:95], v[100:103], a[48:51], v[80:95]
    ds_read_b64_tr_b16 v[116:117], v19 offset:0
    ds_read_b64_tr_b16 v[118:119], v19 offset:1024
    buffer_load_dwordx4 a[16:19], v7, s[48:51], s84 offen offset:2048 sc1
    s_waitcnt vmcnt(7) lgkmcnt(6)
    v_mfma_f32_32x32x16_bf16 v[64:79], v[104:107], a[52:55], v[64:79]
    ds_read_b64_tr_b16 v[96:97], v18 offset:2048
    ds_read_b64_tr_b16 v[98:99], v18 offset:3072
    s_waitcnt lgkmcnt(6)
    v_mfma_f32_32x32x16_bf16 v[80:95], v[108:111], a[52:55], v[80:95]
    ds_read_b64_tr_b16 v[100:101], v19 offset:2048
    ds_read_b64_tr_b16 v[102:103], v19 offset:3072
    buffer_load_dwordx4 a[20:23], v7, s[48:51], s84 offen offset:3072 sc1
    s_add_u32 s84, s84, 4096
    v_mov_b32 v29, 159776
    v_mov_b32 v30, 1
    s_mov_b64 exec, 1
    ds_add_u32 v29, v30
    s_mov_b64 exec, -1
    s_waitcnt vmcnt(7) lgkmcnt(7)
    v_mfma_f32_32x32x16_bf16 v[64:79], v[112:115], a[56:59], v[64:79]
    ds_read_b64_tr_b16 v[104:105], v18 offset:4096
    ds_read_b64_tr_b16 v[106:107], v18 offset:5120
    s_waitcnt lgkmcnt(7)
    v_mfma_f32_32x32x16_bf16 v[80:95], v[116:119], a[56:59], v[80:95]
    ds_read_b64_tr_b16 v[108:109], v19 offset:4096
    ds_read_b64_tr_b16 v[110:111], v19 offset:5120
    buffer_load_dwordx4 a[24:27], v7, s[48:51], s84 offen offset:0 sc1
    s_waitcnt vmcnt(7) lgkmcnt(7)
    v_mfma_f32_32x32x16_bf16 v[64:79], v[96:99], a[60:63], v[64:79]
    ds_read_b64_tr_b16 v[112:113], v18 offset:6144
    ds_read_b64_tr_b16 v[114:115], v18 offset:7168
    s_waitcnt lgkmcnt(7)
    v_mfma_f32_32x32x16_bf16 v[80:95], v[100:103], a[60:63], v[80:95]
    ds_read_b64_tr_b16 v[116:117], v19 offset:6144
    ds_read_b64_tr_b16 v[118:119], v19 offset:7168
    buffer_load_dwordx4 a[28:31], v7, s[48:51], s84 offen offset:1024 sc1
    s_waitcnt vmcnt(7) lgkmcnt(6)
    v_mfma_f32_32x32x16_bf16 v[64:79], v[104:107], a[0:3], v[64:79]
    ds_read_b64_tr_b16 v[96:97], v18 offset:8192
    ds_read_b64_tr_b16 v[98:99], v18 offset:9216
    s_waitcnt lgkmcnt(6)
    v_mfma_f32_32x32x16_bf16 v[80:95], v[108:111], a[0:3], v[80:95]
    ds_read_b64_tr_b16 v[100:101], v19 offset:8192
    ds_read_b64_tr_b16 v[102:103], v19 offset:9216
    buffer_load_dwordx4 a[32:35], v7, s[48:51], s84 offen offset:2048 sc1
    s_waitcnt vmcnt(7) lgkmcnt(6)
    v_mfma_f32_32x32x16_bf16 v[64:79], v[112:115], a[4:7], v[64:79]
    ds_read_b64_tr_b16 v[104:105], v18 offset:10240
    ds_read_b64_tr_b16 v[106:107], v18 offset:11264
    s_waitcnt lgkmcnt(6)
    v_mfma_f32_32x32x16_bf16 v[80:95], v[116:119], a[4:7], v[80:95]
    ds_read_b64_tr_b16 v[108:109], v19 offset:10240
    ds_read_b64_tr_b16 v[110:111], v19 offset:11264
    buffer_load_dwordx4 a[36:39], v7, s[48:51], s84 offen offset:3072 sc1
    s_add_u32 s84, s84, 4096
    s_waitcnt vmcnt(7) lgkmcnt(6)
    v_mfma_f32_32x32x16_bf16 v[64:79], v[96:99], a[8:11], v[64:79]
    ds_read_b64_tr_b16 v[112:113], v18 offset:12288
    ds_read_b64_tr_b16 v[114:115], v18 offset:13312
    s_waitcnt lgkmcnt(6)
    v_mfma_f32_32x32x16_bf16 v[80:95], v[100:103], a[8:11], v[80:95]
    ds_read_b64_tr_b16 v[116:117], v19 offset:12288
    ds_read_b64_tr_b16 v[118:119], v19 offset:13312
    buffer_load_dwordx4 a[40:43], v7, s[48:51], s84 offen offset:0 sc1
    s_waitcnt vmcnt(7) lgkmcnt(6)
    v_mfma_f32_32x32x16_bf16 v[64:79], v[104:107], a[12:15], v[64:79]
    ds_read_b64_tr_b16 v[96:97], v18 offset:14336
    ds_read_b64_tr_b16 v[98:99], v18 offset:15360
    s_waitcnt lgkmcnt(6)
    v_mfma_f32_32x32x16_bf16 v[80:95], v[108:111], a[12:15], v[80:95]
    ds_read_b64_tr_b16 v[100:101], v19 offset:14336
    ds_read_b64_tr_b16 v[102:103], v19 offset:15360
    buffer_load_dwordx4 a[44:47], v7, s[48:51], s84 offen offset:1024 sc1
    s_add_u32 s84, s84, 3723264
    v_mov_b32 v9, s71
    s_mov_b64 exec, -1
    buffer_load_dword v9, v8, s[48:51], 0 offen sc1
    s_mov_b64 exec, -1
    s_waitcnt vmcnt(8) lgkmcnt(6)
    v_mfma_f32_32x32x16_bf16 v[64:79], v[112:115], a[16:19], v[64:79]
    ds_read_b64_tr_b16 v[104:105], v18 offset:16384
    ds_read_b64_tr_b16 v[106:107], v18 offset:17408
    s_waitcnt lgkmcnt(6)
    v_mfma_f32_32x32x16_bf16 v[80:95], v[116:119], a[16:19], v[80:95]
    ds_read_b64_tr_b16 v[108:109], v19 offset:16384
    ds_read_b64_tr_b16 v[110:111], v19 offset:17408
    s_waitcnt vmcnt(7) lgkmcnt(6)
    v_mfma_f32_32x32x16_bf16 v[64:79], v[96:99], a[20:23], v[64:79]
    ds_read_b64_tr_b16 v[112:113], v18 offset:18432
    ds_read_b64_tr_b16 v[114:115], v18 offset:19456
    s_waitcnt lgkmcnt(6)
    v_mfma_f32_32x32x16_bf16 v[80:95], v[100:103], a[20:23], v[80:95]
    ds_read_b64_tr_b16 v[116:117], v19 offset:18432
    ds_read_b64_tr_b16 v[118:119], v19 offset:19456
    s_waitcnt vmcnt(6) lgkmcnt(6)
    v_mfma_f32_32x32x16_bf16 v[64:79], v[104:107], a[24:27], v[64:79]
    ds_read_b64_tr_b16 v[96:97], v18 offset:20480
    ds_read_b64_tr_b16 v[98:99], v18 offset:21504
    s_waitcnt lgkmcnt(6)
    v_mfma_f32_32x32x16_bf16 v[80:95], v[108:111], a[24:27], v[80:95]
    ds_read_b64_tr_b16 v[100:101], v19 offset:20480
    ds_read_b64_tr_b16 v[102:103], v19 offset:21504
    s_waitcnt vmcnt(5) lgkmcnt(6)
    v_mfma_f32_32x32x16_bf16 v[64:79], v[112:115], a[28:31], v[64:79]
    ds_read_b64_tr_b16 v[104:105], v18 offset:22528
    ds_read_b64_tr_b16 v[106:107], v18 offset:23552
    s_waitcnt lgkmcnt(6)
    v_mfma_f32_32x32x16_bf16 v[80:95], v[116:119], a[28:31], v[80:95]
    ds_read_b64_tr_b16 v[108:109], v19 offset:22528
    ds_read_b64_tr_b16 v[110:111], v19 offset:23552
    s_waitcnt vmcnt(4) lgkmcnt(6)
    v_mfma_f32_32x32x16_bf16 v[64:79], v[96:99], a[32:35], v[64:79]
    ds_read_b64_tr_b16 v[112:113], v18 offset:24576
    ds_read_b64_tr_b16 v[114:115], v18 offset:25600
    s_waitcnt lgkmcnt(6)
    v_mfma_f32_32x32x16_bf16 v[80:95], v[100:103], a[32:35], v[80:95]
    ds_read_b64_tr_b16 v[116:117], v19 offset:24576
    ds_read_b64_tr_b16 v[118:119], v19 offset:25600
    s_lshl_b32 s74, s3, 2
    s_sub_u32 s74, 159780, s74
    s_lshl_b32 s75, 4, s3
    v_mov_b32 v29, s74
    ds_read_b32 v24, v29
    s_waitcnt vmcnt(0)
    s_waitcnt lgkmcnt(0)
    v_cmp_ne_u32 vcc, s71, v9
    v_cmp_ne_u32 s[98:99], s75, v24
    s_nop 0
    s_or_b64 vcc, vcc, s[98:99]
    s_mov_b32 s76, 0
    s_cbranch_vccnz L_vlate
    s_mov_b32 s76, 1
    s_mov_b32 s73, 65536
    buffer_load_dword v15, v15, s[48:51], s73 offen sc1
    v_mul_u32_u24 v6, 8192, v5
    v_lshl_add_u32 v6, v4, 4, v6
    s_lshl_b32 s75, s86, 8
    s_mul_i32 s74, s80, 458752
    s_add_u32 s75, s75, s74
    s_cmp_lt_u32 s80, 3
    s_cbranch_scc1 L_v1435
    s_add_u32 m0, s83, 14336
    s_add_u32 s74, s75, 458752
    buffer_load_dwordx4 v6, s[52:55], s74 offen sc1 lds
    s_add_u32 m0, s83, 15360
    s_add_u32 s74, s75, 491520
    buffer_load_dwordx4 v6, s[52:55], s74 offen sc1 lds
L_v1435:
    s_add_u32 m0, s83, 0
    s_nop 0
    buffer_load_dwordx4 v6, s[52:55], s75 offen sc1 lds
    s_add_u32 s75, s75, 32768
    s_add_u32 m0, s83, 1024
    s_nop 0
    buffer_load_dwordx4 v6, s[52:55], s75 offen sc1 lds
    s_add_u32 s75, s75, 32768
    s_add_u32 m0, s83, 2048
    s_nop 0
    buffer_load_dwordx4 v6, s[52:55], s75 offen sc1 lds
    s_add_u32 s75, s75, 32768
    s_add_u32 m0, s83, 3072
    s_nop 0
    buffer_load_dwordx4 v6, s[52:55], s75 offen sc1 lds
    s_add_u32 s75, s75, 32768
    s_waitcnt vmcnt(8) lgkmcnt(6)
    v_mfma_f32_32x32x16_bf16 v[64:79], v[104:107], a[36:39], v[64:79]
    ds_read_b64_tr_b16 v[96:97], v18 offset:26624
    ds_read_b64_tr_b16 v[98:99], v18 offset:27648
    s_waitcnt lgkmcnt(6)
    v_mfma_f32_32x32x16_bf16 v[80:95], v[108:111], a[36:39], v[80:95]
    ds_read_b64_tr_b16 v[100:101], v19 offset:26624
    ds_read_b64_tr_b16 v[102:103], v19 offset:27648
    s_add_u32 m0, s83, 4096
    s_nop 0
    buffer_load_dwordx4 v6, s[52:55], s75 offen sc1 lds
    s_add_u32 s75, s75, 32768
    s_add_u32 m0, s83, 5120
    s_nop 0
    buffer_load_dwordx4 v6, s[52:55], s75 offen sc1 lds
    s_add_u32 s75, s75, 32768
    s_add_u32 m0, s83, 6144
    s_nop 0
    buffer_load_dwordx4 v6, s[52:55], s75 offen sc1 lds
    s_add_u32 s75, s75, 32768
    s_add_u32 m0, s83, 7168
    s_nop 0
    buffer_load_dwordx4 v6, s[52:55], s75 offen sc1 lds
    s_add_u32 s75, s75, 32768
    s_add_u32 m0, s83, 8192
    s_nop 0
    buffer_load_dwordx4 v6, s[52:55], s75 offen sc1 lds
    s_add_u32 s75, s75, 32768
    s_waitcnt vmcnt(12) lgkmcnt(6)
    v_mfma_f32_32x32x16_bf16 v[64:79], v[112:115], a[40:43], v[64:79]
    s_waitcnt lgkmcnt(4)
    v_mfma_f32_32x32x16_bf16 v[80:95], v[116:119], a[40:43], v[80:95]
    s_add_u32 m0, s83, 9216
    s_nop 0
    buffer_load_dwordx4 v6, s[52:55], s75 offen sc1 lds
    s_add_u32 s75, s75, 32768
    s_add_u32 m0, s83, 10240
    s_nop 0
    buffer_load_dwordx4 v6, s[52:55], s75 offen sc1 lds
    s_add_u32 s75, s75, 32768
    s_add_u32 m0, s83, 11264
    s_nop 0
    buffer_load_dwordx4 v6, s[52:55], s75 offen sc1 lds
    s_add_u32 s75, s75, 32768
    s_add_u32 m0, s83, 12288
    s_nop 0
    buffer_load_dwordx4 v6, s[52:55], s75 offen sc1 lds
    s_add_u32 s75, s75, 32768
    s_add_u32 m0, s83, 13312
    s_nop 0
    buffer_load_dwordx4 v6, s[52:55], s75 offen sc1 lds
    s_add_u32 s75, s75, 32768
    s_waitcnt vmcnt(16) lgkmcnt(2)
    v_mfma_f32_32x32x16_bf16 v[64:79], v[96:99], a[44:47], v[64:79]
    s_waitcnt lgkmcnt(0)
    v_mfma_f32_32x32x16_bf16 v[80:95], v[100:103], a[44:47], v[80:95]
    s_branch L_ytail
L_vlate:
    s_waitcnt vmcnt(3) lgkmcnt(6)
    v_mfma_f32_32x32x16_bf16 v[64:79], v[104:107], a[36:39], v[64:79]
    ds_read_b64_tr_b16 v[96:97], v18 offset:26624
    ds_read_b64_tr_b16 v[98:99], v18 offset:27648
    s_waitcnt lgkmcnt(6)
    v_mfma_f32_32x32x16_bf16 v[80:95], v[108:111], a[36:39], v[80:95]
    ds_read_b64_tr_b16 v[100:101], v19 offset:26624
    ds_read_b64_tr_b16 v[102:103], v19 offset:27648
    s_waitcnt vmcnt(2) lgkmcnt(6)
    v_mfma_f32_32x32x16_bf16 v[64:79], v[112:115], a[40:43], v[64:79]
    s_waitcnt lgkmcnt(4)
    v_mfma_f32_32x32x16_bf16 v[80:95], v[116:119], a[40:43], v[80:95]
    s_waitcnt vmcnt(1) lgkmcnt(2)
    v_mfma_f32_32x32x16_bf16 v[64:79], v[96:99], a[44:47], v[64:79]
    s_waitcnt lgkmcnt(0)
    v_mfma_f32_32x32x16_bf16 v[80:95], v[100:103], a[44:47], v[80:95]
    v_mov_b32 v9, s71
    s_mov_b64 exec, -1
    buffer_load_dword v9, v8, s[48:51], 0 offen sc1
    s_mov_b64 exec, -1
L_ytail:
    s_lshl_b32 s73, s2, 2
    s_add_u32 s73, s73, s80
    s_lshl_b32 s73, s73, 12
    s_add_u32 s73, s73, 16777216
    s_lshl_b32 s77, s2, 3
    s_add_u32 s77, s77, s80
    s_lshl_b32 s77, s77, 4
    s_add_u32 s77, s77, 81920
    s_nop 0
    v_cvt_pk_bf16_f32 v48, v64, v65
    v_cvt_pk_bf16_f32 v49, v66, v67
    v_cvt_pk_bf16_f32 v50, v68, v69
    v_cvt_pk_bf16_f32 v51, v70, v71
    buffer_store_dwordx4 v[48:51], v7, s[48:51], s73 offen offset:0 sc1
    v_cvt_pk_bf16_f32 v52, v72, v73
    v_cvt_pk_bf16_f32 v53, v74, v75
    v_cvt_pk_bf16_f32 v54, v76, v77
    v_cvt_pk_bf16_f32 v55, v78, v79
    buffer_store_dwordx4 v[52:55], v7, s[48:51], s73 offen offset:1024 sc1
    v_cvt_pk_bf16_f32 v56, v80, v81
    v_cvt_pk_bf16_f32 v57, v82, v83
    v_cvt_pk_bf16_f32 v58, v84, v85
    v_cvt_pk_bf16_f32 v59, v86, v87
    buffer_store_dwordx4 v[56:59], v7, s[48:51], s73 offen offset:2048 sc1
    v_cvt_pk_bf16_f32 v60, v88, v89
    v_cvt_pk_bf16_f32 v61, v90, v91
    v_cvt_pk_bf16_f32 v62, v92, v93
    v_cvt_pk_bf16_f32 v63, v94, v95
    buffer_store_dwordx4 v[60:63], v7, s[48:51], s73 offen offset:3072 sc1
    s_mov_b32 s85, 0
    s_cmp_eq_u32 s76, 0
    s_cbranch_scc1 L_vlate2
    s_branch L_vin
L_vlate2:
    s_waitcnt vmcnt(4)
    v_cmp_ne_u32 vcc, s71, v9
    s_cbranch_vccz poll36_ok
    s_waitcnt vmcnt(0)
    s_cmp_lg_u32 s85, 0
    s_cbranch_scc1 L_ts37
    s_waitcnt vmcnt(0)
    v_mov_b32 v24, s71
    v_mov_b32 v25, s71
    v_mov_b32 v26, s71
    v_mov_b32 v27, s71
    s_mov_b64 exec, 1
    buffer_store_dwordx4 v[24:27], v7, s[48:51], s77 offen sc1
    s_mov_b64 exec, -1
    s_mov_b32 s85, 1
L_ts37:
    s_mov_b32 s79, 20000
poll36:
    buffer_load_dword v9, v8, s[48:51], 0 offen sc1
    s_mov_b64 exec, -1
    s_waitcnt vmcnt(0)
    v_cmp_ne_u32 vcc, s71, v9
    s_cbranch_vccz poll36_ok
    s_sleep 4
    s_sub_u32 s79, s79, 1
    s_cbranch_scc0 poll36
poll36_ok:
    s_lshl_b32 s74, s3, 2
    s_sub_u32 s74, 159780, s74
    s_lshl_b32 s75, 4, s3
    v_mov_b32 v29, s74
    s_mov_b32 s79, 1280000
swb38:
    s_cmp_lg_u32 s85, 0
    s_cbranch_scc1 L_ts39
    s_getreg_b32 s72, hwreg(HW_REG_IB_STS)
    s_and_b32 s72, s72, 0xc000000f
    s_cmp_gt_u32 s72, 0
    s_cbranch_scc1 L_ts39
    s_waitcnt vmcnt(0)
    v_mov_b32 v24, s71
    v_mov_b32 v25, s71
    v_mov_b32 v26, s71
    v_mov_b32 v27, s71
    s_mov_b64 exec, 1
    buffer_store_dwordx4 v[24:27], v7, s[48:51], s77 offen sc1
    s_mov_b64 exec, -1
    s_mov_b32 s85, 1
L_ts39:
    ds_read_b32 v30, v29
    s_waitcnt lgkmcnt(0)
    v_cmp_gt_u32 vcc, s75, v30
    s_cbranch_vccz swb38_ok
    s_sleep 1
    s_sub_u32 s79, s79, 1
    s_cbranch_scc0 swb38
swb38_ok:
    s_mov_b32 s73, 65536
    buffer_load_dword v15, v15, s[48:51], s73 offen sc1
    v_mul_u32_u24 v6, 8192, v5
    v_lshl_add_u32 v6, v4, 4, v6
    s_lshl_b32 s75, s86, 8
    s_mul_i32 s74, s80, 458752
    s_add_u32 s75, s75, s74
    s_cmp_lt_u32 s80, 3
    s_cbranch_scc1 L_v1440
    s_add_u32 m0, s83, 14336
    s_add_u32 s74, s75, 458752
    buffer_load_dwordx4 v6, s[52:55], s74 offen sc1 lds
    s_add_u32 m0, s83, 15360
    s_add_u32 s74, s75, 491520
    buffer_load_dwordx4 v6, s[52:55], s74 offen sc1 lds
L_v1440:
    s_add_u32 m0, s83, 0
    s_nop 0
    buffer_load_dwordx4 v6, s[52:55], s75 offen sc1 lds
    s_add_u32 s75, s75, 32768
    s_add_u32 m0, s83, 1024
    s_nop 0
    buffer_load_dwordx4 v6, s[52:55], s75 offen sc1 lds
    s_add_u32 s75, s75, 32768
    s_add_u32 m0, s83, 2048
    s_nop 0
    buffer_load_dwordx4 v6, s[52:55], s75 offen sc1 lds
    s_add_u32 s75, s75, 32768
    s_add_u32 m0, s83, 3072
    s_nop 0
    buffer_load_dwordx4 v6, s[52:55], s75 offen sc1 lds
    s_add_u32 s75, s75, 32768
    s_add_u32 m0, s83, 4096
    s_nop 0
    buffer_load_dwordx4 v6, s[52:55], s75 offen sc1 lds
    s_add_u32 s75, s75, 32768
    s_add_u32 m0, s83, 5120
    s_nop 0
    buffer_load_dwordx4 v6, s[52:55], s75 offen sc1 lds
    s_add_u32 s75, s75, 32768
    s_add_u32 m0, s83, 6144
    s_nop 0
    buffer_load_dwordx4 v6, s[52:55], s75 offen sc1 lds
    s_add_u32 s75, s75, 32768
    s_add_u32 m0, s83, 7168
    s_nop 0
    buffer_load_dwordx4 v6, s[52:55], s75 offen sc1 lds
    s_add_u32 s75, s75, 32768
    s_add_u32 m0, s83, 8192
    s_nop 0
    buffer_load_dwordx4 v6, s[52:55], s75 offen sc1 lds
    s_add_u32 s75, s75, 32768
    s_add_u32 m0, s83, 9216
    s_nop 0
    buffer_load_dwordx4 v6, s[52:55], s75 offen sc1 lds
    s_add_u32 s75, s75, 32768
    s_add_u32 m0, s83, 10240
    s_nop 0
    buffer_load_dwordx4 v6, s[52:55], s75 offen sc1 lds
    s_add_u32 s75, s75, 32768
    s_add_u32 m0, s83, 11264
    s_nop 0
    buffer_load_dwordx4 v6, s[52:55], s75 offen sc1 lds
    s_add_u32 s75, s75, 32768
    s_add_u32 m0, s83, 12288
    s_nop 0
    buffer_load_dwordx4 v6, s[52:55], s75 offen sc1 lds
    s_add_u32 s75, s75, 32768
    s_add_u32 m0, s83, 13312
    s_nop 0
    buffer_load_dwordx4 v6, s[52:55], s75 offen sc1 lds
    s_add_u32 s75, s75, 32768
    s_mov_b32 s85, 0
    s_cmp_lg_u32 s85, 0
    s_cbranch_scc1 L_ts41
    s_waitcnt vmcnt(15)
    v_mov_b32 v24, s71
    v_mov_b32 v25, s71
    v_mov_b32 v26, s71
    v_mov_b32 v27, s71
    s_mov_b64 exec, 1
    buffer_store_dwordx4 v[24:27], v7, s[48:51], s77 offen sc1
    s_mov_b64 exec, -1
    s_mov_b32 s85, 1
L_ts41:
    s_waitcnt vmcnt(1)
L_vin:
    v_lshl_add_u32 v18, v2, 2, s83
    v_lshl_add_u32 v18, v3, 10, v18
    v_add_u32 v19, 128, v18
    s_and_b32 s72, s80, 1
    s_mul_i32 s72, s72, 28672
    s_sub_u32 s72, 14336, s72
    v_add_u32 v20, s72, v18
    v_add_u32 v21, s72, v19
    v_add_u32 v32, s83, v7
    v_xor_b32 v33, 64, v32
    v_xor_b32 v34, 128, v32
    v_xor_b32 v35, 192, v32
    s_lshl_b32 s74, s3, 2
    s_add_u32 s74, s74, 159800
    s_waitcnt vmcnt(16)
    ds_read2st64_b32 v[96:97], v18 offset0:0 offset1:1
    ds_read2st64_b32 v[98:99], v18 offset0:2 offset1:3
    ds_read2st64_b32 v[100:101], v19 offset0:0 offset1:1
    ds_read2st64_b32 v[102:103], v19 offset0:2 offset1:3
    s_waitcnt vmcnt(14)
    ds_read2st64_b32 v[104:105], v18 offset0:8 offset1:9
    ds_read2st64_b32 v[106:107], v18 offset0:10 offset1:11
    ds_read2st64_b32 v[108:109], v19 offset0:8 offset1:9
    ds_read2st64_b32 v[110:111], v19 offset0:10 offset1:11
    s_waitcnt vmcnt(12)
    ds_read2st64_b32 v[112:113], v18 offset0:16 offset1:17
    ds_read2st64_b32 v[114:115], v18 offset0:18 offset1:19
    ds_read2st64_b32 v[116:117], v19 offset0:16 offset1:17
    ds_read2st64_b32 v[118:119], v19 offset0:18 offset1:19
    s_waitcnt lgkmcnt(8)
    v_mfma_f32_32x32x16_bf16 v[64:79], v[128:131], v[96:99], 0
    v_mfma_f32_32x32x16_bf16 v[80:95], v[128:131], v[100:103], 0
    s_waitcnt vmcnt(10)
    ds_read2st64_b32 v[96:97], v18 offset0:24 offset1:25
    ds_read2st64_b32 v[98:99], v18 offset0:26 offset1:27
    ds_read2st64_b32 v[100:101], v19 offset0:24 offset1:25
    ds_read2st64_b32 v[102:103], v19 offset0:26 offset1:27
    s_waitcnt lgkmcnt(8)
    v_mfma_f32_32x32x16_bf16 v[64:79], v[132:135], v[104:107], v[64:79]
    v_mfma_f32_32x32x16_bf16 v[80:95], v[132:135], v[108:111], v[80:95]
    s_waitcnt vmcnt(8)
    ds_read2st64_b32 v[104:105], v18 offset0:32 offset1:33
    ds_read2st64_b32 v[106:107], v18 offset0:34 offset1:35
    ds_read2st64_b32 v[108:109], v19 offset0:32 offset1:33
    ds_read2st64_b32 v[110:111], v19 offset0:34 offset1:35
    s_waitcnt lgkmcnt(8)
    v_mfma_f32_32x32x16_bf16 v[64:79], v[136:139], v[112:115], v[64:79]
    v_mfma_f32_32x32x16_bf16 v[80:95], v[136:139], v[116:119], v[80:95]
    s_cmp_lg_u32 s85, 0
    s_cbranch_scc1 L_ts42
    s_getreg_b32 s72, hwreg(HW_REG_IB_STS)
    s_and_b32 s72, s72, 0xc000000f
    s_cmp_gt_u32 s72, 0
    s_cbranch_scc1 L_ts42
    s_waitcnt vmcnt(0)
    v_mov_b32 v24, s71
    v_mov_b32 v25, s71
    v_mov_b32 v26, s71
    v_mov_b32 v27, s71
    s_mov_b64 exec, 1
    buffer_store_dwordx4 v[24:27], v7, s[48:51], s77 offen sc1
    s_mov_b64 exec, -1
    s_mov_b32 s85, 1
L_ts42:
    s_waitcnt vmcnt(6)
    ds_read2st64_b32 v[112:113], v18 offset0:40 offset1:41
    ds_read2st64_b32 v[114:115], v18 offset0:42 offset1:43
    ds_read2st64_b32 v[116:117], v19 offset0:40 offset1:41
    ds_read2st64_b32 v[118:119], v19 offset0:42 offset1:43
    s_waitcnt lgkmcnt(8)
    v_mfma_f32_32x32x16_bf16 v[64:79], v[140:143], v[96:99], v[64:79]
    v_mfma_f32_32x32x16_bf16 v[80:95], v[140:143], v[100:103], v[80:95]
    s_waitcnt vmcnt(4)
    v_mov_b32 v29, s74
    v_mov_b32 v30, 1
    s_mov_b64 exec, 1
    ds_add_u32 v29, v30
    s_mov_b64 exec, -1
    ds_read2st64_b32 v[96:97], v18 offset0:48 offset1:49
    ds_read2st64_b32 v[98:99], v18 offset0:50 offset1:51
    ds_read2st64_b32 v[100:101], v19 offset0:48 offset1:49
    ds_read2st64_b32 v[102:103], v19 offset0:50 offset1:51
    s_waitcnt lgkmcnt(9)
    v_mfma_f32_32x32x16_bf16 v[64:79], v[144:147], v[104:107], v[64:79]
    v_mfma_f32_32x32x16_bf16 v[80:95], v[144:147], v[108:111], v[80:95]
    v_mov_b32 v29, s74
    s_mov_b32 s79, 1280000
swb43:
    ds_read_b32 v30, v29
    s_waitcnt lgkmcnt(0)
    v_cmp_gt_u32 vcc, 2, v30
    s_cbranch_vccz swb43_ok
    s_sleep 1
    s_sub_u32 s79, s79, 1
    s_cbranch_scc0 swb43
swb43_ok:
    ds_read2st64_b32 v[104:105], v20 offset0:0 offset1:1
    ds_read2st64_b32 v[106:107], v20 offset0:2 offset1:3
    ds_read2st64_b32 v[108:109], v21 offset0:0 offset1:1
    ds_read2st64_b32 v[110:111], v21 offset0:2 offset1:3
    s_waitcnt lgkmcnt(9)
    v_mfma_f32_32x32x16_bf16 v[64:79], v[148:151], v[112:115], v[64:79]
    v_mfma_f32_32x32x16_bf16 v[80:95], v[148:151], v[116:119], v[80:95]
    s_cmp_lg_u32 s85, 0
    s_cbranch_scc1 L_ts44
    s_getreg_b32 s72, hwreg(HW_REG_IB_STS)
    s_and_b32 s72, s72, 0xc000000f
    s_cmp_gt_u32 s72, 0
    s_cbranch_scc1 L_ts44
    s_waitcnt vmcnt(0)
    v_mov_b32 v24, s71
    v_mov_b32 v25, s71
    v_mov_b32 v26, s71
    v_mov_b32 v27, s71
    s_mov_b64 exec, 1
    buffer_store_dwordx4 v[24:27], v7, s[48:51], s77 offen sc1
    s_mov_b64 exec, -1
    s_mov_b32 s85, 1
L_ts44:
    ds_read2st64_b32 v[112:113], v20 offset0:8 offset1:9
    ds_read2st64_b32 v[114:115], v20 offset0:10 offset1:11
    ds_read2st64_b32 v[116:117], v21 offset0:8 offset1:9
    ds_read2st64_b32 v[118:119], v21 offset0:10 offset1:11
    s_waitcnt lgkmcnt(8)
    v_mfma_f32_32x32x16_bf16 v[64:79], v[152:155], v[96:99], v[64:79]
    v_mfma_f32_32x32x16_bf16 v[80:95], v[152:155], v[100:103], v[80:95]
    ds_read2st64_b32 v[96:97], v20 offset0:16 offset1:17
    ds_read2st64_b32 v[98:99], v20 offset0:18 offset1:19
    ds_read2st64_b32 v[100:101], v21 offset0:16 offset1:17
    ds_read2st64_b32 v[102:103], v21 offset0:18 offset1:19
    s_waitcnt lgkmcnt(8)
    v_mfma_f32_32x32x16_bf16 v[64:79], v[160:163], v[104:107], v[64:79]
    v_mfma_f32_32x32x16_bf16 v[80:95], v[160:163], v[108:111], v[80:95]
    ds_read2st64_b32 v[104:105], v20 offset0:24 offset1:25
    ds_read2st64_b32 v[106:107], v20 offset0:26 offset1:27
    ds_read2st64_b32 v[108:109], v21 offset0:24 offset1:25
    ds_read2st64_b32 v[110:111], v21 offset0:26 offset1:27
    s_waitcnt lgkmcnt(8)
    v_mfma_f32_32x32x16_bf16 v[64:79], v[164:167], v[112:115], v[64:79]
    v_mfma_f32_32x32x16_bf16 v[80:95], v[164:167], v[116:119], v[80:95]
    s_cmp_lg_u32 s85, 0
    s_cbranch_scc1 L_ts45
    s_getreg_b32 s72, hwreg(HW_REG_IB_STS)
    s_and_b32 s72, s72, 0xc000000f
    s_cmp_gt_u32 s72, 0
    s_cbranch_scc1 L_ts45
    s_waitcnt vmcnt(0)
    v_mov_b32 v24, s71
    v_mov_b32 v25, s71
    v_mov_b32 v26, s71
    v_mov_b32 v27, s71
    s_mov_b64 exec, 1
    buffer_store_dwordx4 v[24:27], v7, s[48:51], s77 offen sc1
    s_mov_b64 exec, -1
    s_mov_b32 s85, 1
L_ts45:
    ds_read2st64_b32 v[112:113], v20 offset0:32 offset1:33
    ds_read2st64_b32 v[114:115], v20 offset0:34 offset1:35
    ds_read2st64_b32 v[116:117], v21 offset0:32 offset1:33
    ds_read2st64_b32 v[118:119], v21 offset0:34 offset1:35
    s_waitcnt lgkmcnt(8)
    v_mfma_f32_32x32x16_bf16 v[64:79], v[168:171], v[96:99], v[64:79]
    v_mfma_f32_32x32x16_bf16 v[80:95], v[168:171], v[100:103], v[80:95]
    ds_read2st64_b32 v[96:97], v20 offset0:40 offset1:41
    ds_read2st64_b32 v[98:99], v20 offset0:42 offset1:43
    ds_read2st64_b32 v[100:101], v21 offset0:40 offset1:41
    ds_read2st64_b32 v[102:103], v21 offset0:42 offset1:43
    s_waitcnt lgkmcnt(8)
    v_mfma_f32_32x32x16_bf16 v[64:79], v[172:175], v[104:107], v[64:79]
    v_mfma_f32_32x32x16_bf16 v[80:95], v[172:175], v[108:111], v[80:95]
    ds_read2st64_b32 v[104:105], v20 offset0:48 offset1:49
    ds_read2st64_b32 v[106:107], v20 offset0:50 offset1:51
    ds_read2st64_b32 v[108:109], v21 offset0:48 offset1:49
    ds_read2st64_b32 v[110:111], v21 offset0:50 offset1:51
    s_waitcnt lgkmcnt(8)
    v_mfma_f32_32x32x16_bf16 v[64:79], v[176:179], v[112:115], v[64:79]
    v_mfma_f32_32x32x16_bf16 v[80:95], v[176:179], v[116:119], v[80:95]
    s_cmp_lg_u32 s85, 0
    s_cbranch_scc1 L_ts46
    s_getreg_b32 s72, hwreg(HW_REG_IB_STS)
    s_and_b32 s72, s72, 0xc000000f
    s_cmp_gt_u32 s72, 0
    s_cbranch_scc1 L_ts46
    s_waitcnt vmcnt(0)
    v_mov_b32 v24, s71
    v_mov_b32 v25, s71
    v_mov_b32 v26, s71
    v_mov_b32 v27, s71
    s_mov_b64 exec, 1
    buffer_store_dwordx4 v[24:27], v7, s[48:51], s77 offen sc1
    s_mov_b64 exec, -1
    s_mov_b32 s85, 1
L_ts46:
    s_waitcnt lgkmcnt(4)
    v_mfma_f32_32x32x16_bf16 v[64:79], v[180:183], v[96:99], v[64:79]
    v_mfma_f32_32x32x16_bf16 v[80:95], v[180:183], v[100:103], v[80:95]
    s_waitcnt lgkmcnt(0)
    v_mfma_f32_32x32x16_bf16 v[64:79], v[184:187], v[104:107], v[64:79]
    v_mfma_f32_32x32x16_bf16 v[80:95], v[184:187], v[108:111], v[80:95]
    s_cmp_lg_u32 s80, 3
    s_cbranch_scc1 L_n847
    ds_read2st64_b32 v[96:97], v18 offset0:56 offset1:57
    ds_read2st64_b32 v[98:99], v18 offset0:58 offset1:59
    ds_read2st64_b32 v[100:101], v19 offset0:56 offset1:57
    ds_read2st64_b32 v[102:103], v19 offset0:58 offset1:59
    s_waitcnt lgkmcnt(0)
    v_mfma_f32_32x32x16_bf16 v[64:79], v[156:159], v[96:99], v[64:79]
    v_mfma_f32_32x32x16_bf16 v[80:95], v[156:159], v[100:103], v[80:95]
L_n847:
    s_cmp_lg_u32 s80, 2
    s_cbranch_scc1 L_n848
    ds_read2st64_b32 v[96:97], v20 offset0:56 offset1:57
    ds_read2st64_b32 v[98:99], v20 offset0:58 offset1:59
    ds_read2st64_b32 v[100:101], v21 offset0:56 offset1:57
    ds_read2st64_b32 v[102:103], v21 offset0:58 offset1:59
    s_waitcnt lgkmcnt(0)
    v_mfma_f32_32x32x16_bf16 v[64:79], v[188:191], v[96:99], v[64:79]
    v_mfma_f32_32x32x16_bf16 v[80:95], v[188:191], v[100:103], v[80:95]
L_n848:
    s_cmp_lg_u32 s85, 0
    s_cbranch_scc1 L_ts49
    s_waitcnt vmcnt(0)
    v_mov_b32 v24, s71
    v_mov_b32 v25, s71
    v_mov_b32 v26, s71
    v_mov_b32 v27, s71
    s_mov_b64 exec, 1
    buffer_store_dwordx4 v[24:27], v7, s[48:51], s77 offen sc1
    s_mov_b64 exec, -1
    s_mov_b32 s85, 1
L_ts49:
    v_mov_b32 v29, s74
    v_mov_b32 v30, 1
    s_mov_b64 exec, 1
    ds_add_u32 v29, v30
    s_mov_b64 exec, -1
    v_mov_b32 v29, s74
    s_mov_b32 s79, 1280000
swb50:
    ds_read_b32 v30, v29
    s_waitcnt lgkmcnt(0)
    v_cmp_gt_u32 vcc, 4, v30
    s_cbranch_vccz swb50_ok
    s_sleep 1
    s_sub_u32 s79, s79, 1
    s_cbranch_scc0 swb50
swb50_ok:
    ds_write_b128 v32, v[64:67] offset:0
    ds_write_b128 v33, v[68:71] offset:1024
    ds_write_b128 v34, v[72:75] offset:2048
    ds_write_b128 v35, v[76:79] offset:3072
    ds_write_b128 v32, v[80:83] offset:4096
    ds_write_b128 v33, v[84:87] offset:5120
    ds_write_b128 v34, v[88:91] offset:6144
    ds_write_b128 v35, v[92:95] offset:7168
L_fin3:
    v_sub_f32 v15, 1.0, v15
    v_cvt_pk_bf16_f32 v15, v15, v15
    v_lshlrev_b32 v15, 16, v15
    v_add_f32 v15, v15, v15
    v_add_u32 v44, 131072, v22
    s_lshl_b32 s73, s66, 7
    s_waitcnt lgkmcnt(0)
    s_barrier
    ds_read_b128 v[64:67], v16 offset:0
    ds_read_b128 v[68:71], v16 offset:512
    ds_read_b128 v[72:75], v16 offset:16384
    ds_read_b128 v[76:79], v16 offset:16896
    ds_read_b128 v[80:83], v22 offset:32768
    ds_read_b128 v[84:87], v22 offset:33280
    ds_read_b128 v[88:91], v44 offset:0
    ds_read_b128 v[92:95], v44 offset:512
    s_waitcnt lgkmcnt(4)
    v_pk_add_f32 v[64:65], v[64:65], v[72:73]
    v_pk_add_f32 v[66:67], v[66:67], v[74:75]
    v_pk_add_f32 v[68:69], v[68:69], v[76:77]
    v_pk_add_f32 v[70:71], v[70:71], v[78:79]
    s_waitcnt lgkmcnt(0)
    v_pk_add_f32 v[80:81], v[80:81], v[88:89]
    v_pk_add_f32 v[82:83], v[82:83], v[90:91]
    v_pk_add_f32 v[84:85], v[84:85], v[92:93]
    v_pk_add_f32 v[86:87], v[86:87], v[94:95]
    v_fma_f32 v48, v64, v15, v80
    v_fma_f32 v49, v65, v15, v81
    v_fma_f32 v50, v66, v15, v82
    v_fma_f32 v51, v67, v15, v83
    v_fma_f32 v52, v68, v15, v84
    v_fma_f32 v53, v69, v15, v85
    v_fma_f32 v54, v70, v15, v86
    v_fma_f32 v55, v71, v15, v87
    v_cvt_pk_bf16_f32 v64, v48, v49
    v_cvt_pk_bf16_f32 v65, v50, v51
    v_cvt_pk_bf16_f32 v66, v52, v53
    v_cvt_pk_bf16_f32 v67, v54, v55
    buffer_store_dwordx4 v[64:67], v12, s[44:47], s73 offen sc1 nt
    s_add_u32 s72, s2, s64
    s_cmp_eq_u32 s72, 0
    s_cbranch_scc0 L_fin
    s_mov_b32 s72, 0
    v_mov_b32 v26, s71
    s_mov_b64 exec, 1
    buffer_store_dword v26, v7, s[48:51], s72 offen sc1
    s_mov_b64 exec, -1
    s_branch L_fin
L_y1:
    s_setprio 2
    v_bfe_u32 v32, v1, 2, 2
    v_lshlrev_b32 v33, 7, v32
    v_and_b32 v34, 2, v32
    v_lshl_add_u32 v33, v34, 5, v33
    v_and_b32 v34, 16, v1
    v_lshl_add_u32 v33, v34, 1, v33
    v_and_b32 v32, 3, v1
    v_lshl_add_u32 v33, v32, 3, v33
    v_lshl_add_u32 v16, v3, 10, v33
    s_mul_i32 s72, s81, 57344
    s_add_u32 s72, s72, 16384
    v_add_u32 v16, s72, v16
    v_xor_b32 v17, 64, v16
    v_lshl_add_u32 v18, v3, 9, v33
    s_lshl_b32 s72, s3, 6
    v_xor_b32 v18, s72, v18
    s_mul_i32 s72, s3, 28672
    v_add_u32 v18, s72, v18
    v_xor_b32 v19, 64, v18
    v_bfe_u32 v33, v1, 2, 3
    v_and_b32 v34, 4, v33
    v_xor_b32 v34, v34, v32
    v_xor_b32 v34, v34, v3
    v_lshlrev_b32 v34, 4, v34
    v_lshl_add_u32 v34, v33, 7, v34
    v_lshl_add_u32 v34, v32, 10, v34
    v_add_u32 v12, s20, v34
    v_xor_b32 v13, 32, v12
    v_xor_b32 v14, 64, v12
    v_xor_b32 v15, 96, v12
    s_waitcnt vmcnt(8) lgkmcnt(0)
    s_barrier
    ds_read_b128 a[0:3], v12 offset:32768
    ds_read_b128 a[4:7], v13 offset:32768
    ds_read_b128 a[8:11], v14 offset:32768
    ds_read_b128 a[12:15], v15 offset:32768
    s_add_u32 m0, s20, 81920
    s_nop 0
    buffer_load_dwordx4 v176, s[28:31], s75 offen lds
    s_add_u32 m0, s20, 82944
    s_nop 0
    buffer_load_dwordx4 v177, s[28:31], s75 offen lds
    s_add_u32 m0, s20, 83968
    s_nop 0
    buffer_load_dwordx4 v178, s[28:31], s75 offen lds
    s_add_u32 m0, s20, 84992
    s_nop 0
    buffer_load_dwordx4 v179, s[28:31], s75 offen lds
    s_add_u32 s75, s75, 128
    s_mov_b32 s36, s14
    s_mov_b32 s37, s15
    s_mov_b32 s38, 3584
    s_mov_b32 s39, 0x00020000
    v_lshlrev_b32 v6, 1, v1
    s_lshl_b32 s72, s69, 8
    s_lshl_b32 s73, s81, 7
    s_add_u32 s72, s72, s73
    buffer_load_ushort v48, v6, s[36:39], s72 offen
    s_mov_b32 s48, s24
    s_mov_b32 s49, s25
    s_mov_b32 s50, 20971520
    s_mov_b32 s51, 0x00020000
    s_mov_b64 exec, 1
    buffer_load_dword v23, v7, s[48:51], 0 offen
    s_mov_b64 exec, -1
    s_mov_b32 s40, s16
    s_mov_b32 s41, s17
    s_mov_b32 s42, 1605632
    s_mov_b32 s43, 0x00020000
    s_mov_b32 s44, s26
    s_mov_b32 s45, s27
    s_mov_b32 s46, 1835008
    s_mov_b32 s47, 0x00020000
    s_add_u32 s52, s24, 6291456
    s_addc_u32 s53, s25, 0
    s_mov_b32 s54, 1843200
    s_mov_b32 s55, 0x00020000
    s_waitcnt vmcnt(10) lgkmcnt(0)
    s_barrier
    ds_read_b128 a[16:19], v12 offset:49152
    ds_read_b128 a[20:23], v13 offset:49152
    ds_read_b128 a[24:27], v14 offset:49152
    ds_read_b128 a[28:31], v15 offset:49152
    s_add_u32 m0, s20, 98304
    s_nop 0
    buffer_load_dwordx4 v176, s[28:31], s75 offen lds
    s_add_u32 m0, s20, 99328
    s_nop 0
    buffer_load_dwordx4 v177, s[28:31], s75 offen lds
    s_add_u32 m0, s20, 100352
    s_nop 0
    buffer_load_dwordx4 v178, s[28:31], s75 offen lds
    s_add_u32 m0, s20, 101376
    s_nop 0
    buffer_load_dwordx4 v179, s[28:31], s75 offen lds
    s_add_u32 s75, s75, 128
    v_mov_b32 v49, 0
    v_mov_b32 v53, 0
    v_mov_b32 v57, 0
    v_mov_b32 v50, 0
    v_mov_b32 v54, 0
    v_mov_b32 v58, 0
    v_mov_b32 v51, 0
    v_mov_b32 v55, 0
    v_mov_b32 v59, 0
    v_mul_u32_u24 v56, 0x3f80, v3
    v_sub_u32 v52, 0x3f80, v56
    s_mov_b32 s88, 0xbfb8aa3b
    s_mov_b32 s89, 0xbfb8aa3b
    s_mul_i32 s84, s70, 57
    s_mul_i32 s73, s81, 3648
    s_add_u32 s84, s84, s73
    s_lshl_b32 s73, s69, 2
    s_add_u32 s84, s84, s73
    s_lshl_b32 s84, s84, 10
    s_add_u32 s84, s84, 8388608
    s_lshl_b32 s77, s70, 1
    s_add_u32 s77, s77, s81
    s_lshl_b32 s77, s77, 4
    s_add_u32 s77, s77, s69
    s_lshl_b32 s77, s77, 2
    s_lshr_b32 s73, s77, 6
    s_mul_i32 s73, s73, 64
    s_add_u32 s77, s77, s73
    s_add_u32 s77, s77, 16384
    s_and_b32 s23, s67, 1
    s_mul_i32 s73, s23, 896
    s_lshl_b32 s74, s80, 4
    s_add_u32 s73, s73, s74
    s_mul_i32 s82, s73, 896
    s_lshl_b32 s73, s66, 7
    s_add_u32 s82, s82, s73
    s_lshl_b32 s86, s68, 1
    s_add_u32 s86, s86, s23
    s_xor_b32 s73, s81, 1
    s_lshl_b32 s90, s73, 1
    s_add_u32 s90, s90, s3
    s_xor_b32 s73, s86, s81
    s_lshl_b32 s91, s73, 1
    s_and_b32 s73, s80, 1
    s_add_u32 s91, s91, s73
    s_mul_i32 s83, s73, 14336
    s_mul_i32 s73, s3, 98304
    s_sub_u32 s73, 131072, s73
    s_add_u32 s83, s83, s73
    s_waitcnt vmcnt(10) lgkmcnt(0)
    s_barrier
    v_add_u32 v12, 0x10000, v12
    v_add_u32 v13, 0x10000, v13
    v_add_u32 v14, 0x10000, v14
    v_add_u32 v15, 0x10000, v15
    ds_read_b128 a[32:35], v12 offset:0
    ds_read_b128 a[36:39], v13 offset:0
    ds_read_b128 a[40:43], v14 offset:0
    ds_read_b128 a[44:47], v15 offset:0
    s_add_u32 m0, s20, 114688
    s_nop 0
    buffer_load_dwordx4 v176, s[28:31], s75 offen lds
    s_add_u32 m0, s20, 115712
    s_nop 0
    buffer_load_dwordx4 v177, s[28:31], s75 offen lds
    s_add_u32 m0, s20, 116736
    s_nop 0
    buffer_load_dwordx4 v178, s[28:31], s75 offen lds
    s_add_u32 m0, s20, 117760
    s_nop 0
    buffer_load_dwordx4 v179, s[28:31], s75 offen lds
    s_add_u32 s75, s75, 128
    s_waitcnt vmcnt(10) lgkmcnt(0)
    s_barrier
    ds_read_b128 a[48:51], v12 offset:16384
    ds_read_b128 a[52:55], v13 offset:16384
    ds_read_b128 a[56:59], v14 offset:16384
    ds_read_b128 a[60:63], v15 offset:16384
    s_add_u32 m0, s20, 0
    s_nop 0
    buffer_load_dwordx4 v176, s[28:31], s75 offen lds
    s_add_u32 m0, s20, 1024
    s_nop 0
    buffer_load_dwordx4 v177, s[28:31], s75 offen lds
    s_add_u32 m0, s20, 2048
    s_nop 0
    buffer_load_dwordx4 v178, s[28:31], s75 offen lds
    s_add_u32 m0, s20, 3072
    s_nop 0
    buffer_load_dwordx4 v179, s[28:31], s75 offen lds
    s_add_u32 s75, s75, 128
    s_waitcnt vmcnt(8) lgkmcnt(0)
    s_barrier
    ds_read_b128 v[128:131], v12 offset:32768
    ds_read_b128 v[132:135], v13 offset:32768
    ds_read_b128 v[136:139], v14 offset:32768
    ds_read_b128 v[140:143], v15 offset:32768
    s_add_u32 m0, s21, 16384
    s_nop 0
    buffer_load_dwordx4 v10, s[32:35], s76 offen lds
    s_add_u32 s76, s76, 28672
    s_add_u32 m0, s21, 17408
    s_nop 0
    buffer_load_dwordx4 v10, s[32:35], s76 offen lds
    s_add_u32 s76, s76, 200704
    s_add_u32 m0, s21, 24576
    s_nop 0
    buffer_load_dwordx4 v10, s[32:35], s76 offen lds
    s_add_u32 s76, s76, 28672
    s_add_u32 m0, s21, 25600
    s_nop 0
    buffer_load_dwordx4 v10, s[32:35], s76 offen lds
    s_add_u32 s76, s76, 200704
    s_waitcnt vmcnt(8) lgkmcnt(0)
    s_barrier
    ds_read_b128 v[144:147], v12 offset:49152
    ds_read_b128 v[148:151], v13 offset:49152
    ds_read_b128 v[152:155], v14 offset:49152
    ds_read_b128 v[156:159], v15 offset:49152
    s_add_u32 m0, s21, 32768
    s_nop 0
    buffer_load_dwordx4 v10, s[32:35], s76 offen lds
    s_add_u32 s76, s76, 28672
    s_add_u32 m0, s21, 33792
    s_nop 0
    buffer_load_dwordx4 v10, s[32:35], s76 offen lds
    s_add_u32 s76, s76, 200704
    s_add_u32 m0, s21, 40960
    s_nop 0
    buffer_load_dwordx4 v10, s[32:35], s76 offen lds
    s_add_u32 s76, s76, 28672
    s_add_u32 m0, s21, 41984
    s_nop 0
    buffer_load_dwordx4 v10, s[32:35], s76 offen lds
    s_add_u32 s76, s76, 200704
    s_waitcnt vmcnt(8) lgkmcnt(0)
    s_barrier
    v_subrev_u32 v12, 0x10000, v12
    v_subrev_u32 v13, 0x10000, v13
    v_subrev_u32 v14, 0x10000, v14
    v_subrev_u32 v15, 0x10000, v15
    ds_read_b128 v[160:163], v12 offset:0
    ds_read_b128 v[164:167], v13 offset:0
    ds_read_b128 v[168:171], v14 offset:0
    ds_read_b128 v[172:175], v15 offset:0
    s_add_u32 m0, s21, 49152
    s_nop 0
    buffer_load_dwordx4 v10, s[32:35], s76 offen lds
    s_add_u32 s76, s76, 28672
    s_add_u32 m0, s21, 50176
    s_nop 0
    buffer_load_dwordx4 v10, s[32:35], s76 offen lds
    s_add_u32 s76, s76, 200704
    s_add_u32 m0, s21, 57344
    s_nop 0
    buffer_load_dwordx4 v10, s[32:35], s76 offen lds
    s_add_u32 s76, s76, 28672
    s_add_u32 m0, s21, 58368
    s_nop 0
    buffer_load_dwordx4 v10, s[32:35], s76 offen lds
    s_add_u32 s76, s76, 200704
    s_waitcnt vmcnt(8) lgkmcnt(0)
    s_barrier
    s_add_u32 m0, s21, 65536
    s_nop 0
    buffer_load_dwordx4 v10, s[32:35], s76 offen lds
    s_add_u32 s76, s76, 28672
    s_add_u32 m0, s21, 66560
    s_nop 0
    buffer_load_dwordx4 v10, s[32:35], s76 offen lds
    s_add_u32 s76, s76, 200704
    s_add_u32 m0, s21, 73728
    s_nop 0
    buffer_load_dwordx4 v10, s[32:35], s22 offen lds
    s_add_u32 s22, s22, 28672
    s_add_u32 m0, s21, 74752
    s_nop 0
    buffer_load_dwordx4 v10, s[32:35], s22 offen lds
    s_add_u32 s22, s22, 200704
    s_waitcnt vmcnt(28)
    v_readfirstlane_b32 s71, v23
    s_nop 0
    s_mul_i32 s71, s71, 1664525
    s_add_u32 s71, s71, 1013904223
    s_mov_b32 s92, s71
    s_mov_b32 s93, s71
    v_mfma_f32_32x32x16_bf16 v[64:79], v[48:51], v[52:55], 0
    v_mfma_f32_32x32x16_bf16 v[80:95], v[48:51], v[56:59], 0
    s_waitcnt vmcnt(8) lgkmcnt(0)
    s_barrier
    s_add_u32 m0, s21, 81920
    s_nop 0
    buffer_load_dwordx4 v10, s[32:35], s22 offen lds
    s_add_u32 s22, s22, 28672
    s_add_u32 m0, s21, 82944
    s_nop 0
    buffer_load_dwordx4 v10, s[32:35], s22 offen lds
    s_add_u32 s22, s22, 200704
    s_add_u32 m0, s21, 90112
    s_nop 0
    buffer_load_dwordx4 v10, s[32:35], s22 offen lds
    s_add_u32 s22, s22, 28672
    s_add_u32 m0, s21, 91136
    s_nop 0
    buffer_load_dwordx4 v10, s[32:35], s22 offen lds
    s_add_u32 s22, s22, 200704
    s_waitcnt vmcnt(8) lgkmcnt(0)
    s_barrier
    s_add_u32 m0, s21, 98304
    s_nop 0
    buffer_load_dwordx4 v10, s[32:35], s22 offen lds
    s_add_u32 s22, s22, 28672
    s_add_u32 m0, s21, 99328
    s_nop 0
    buffer_load_dwordx4 v10, s[32:35], s22 offen lds
    s_add_u32 s22, s22, 200704
    s_add_u32 m0, s21, 106496
    s_nop 0
    buffer_load_dwordx4 v10, s[32:35], s22 offen lds
    s_add_u32 s22, s22, 28672
    s_add_u32 m0, s21, 107520
    s_nop 0
    buffer_load_dwordx4 v10, s[32:35], s22 offen lds
    s_add_u32 s22, s22, 200704
    s_add_u32 m0, s21, 114688
    s_nop 0
    buffer_load_dwordx4 v10, s[32:35], s22 offen lds
    s_add_u32 s22, s22, 28672
    s_add_u32 m0, s21, 115712
    s_nop 0
    buffer_load_dwordx4 v10, s[32:35], s22 offen lds
    s_add_u32 s22, s22, 200704
    s_add_u32 m0, s21, 122880
    s_nop 0
    buffer_load_dwordx4 v10, s[32:35], s22 offen lds
    s_add_u32 s22, s22, 28672
    s_add_u32 m0, s21, 123904
    s_nop 0
    buffer_load_dwordx4 v10, s[32:35], s22 offen lds
    s_add_u32 s22, s22, 200704
    s_waitcnt vmcnt(8)
    s_barrier
    s_setprio 1
    ds_read_b64_tr_b16 v[96:97], v16 offset:0
    ds_read_b64_tr_b16 v[98:99], v16 offset:512
    ds_read_b64_tr_b16 v[100:101], v17 offset:0
    ds_read_b64_tr_b16 v[102:103], v17 offset:512
    ds_read_b64_tr_b16 v[104:105], v16 offset:2048
    ds_read_b64_tr_b16 v[106:107], v16 offset:2560
    ds_read_b64_tr_b16 v[108:109], v17 offset:2048
    ds_read_b64_tr_b16 v[110:111], v17 offset:2560
    s_waitcnt lgkmcnt(6)
    v_mfma_f32_32x32x16_bf16 v[64:79], v[96:99], a[0:3], v[64:79]
    ds_read_b64_tr_b16 v[112:113], v16 offset:4096
    ds_read_b64_tr_b16 v[114:115], v16 offset:4608
    s_waitcnt lgkmcnt(6)
    v_mfma_f32_32x32x16_bf16 v[80:95], v[100:103], a[0:3], v[80:95]
    ds_read_b64_tr_b16 v[116:117], v17 offset:4096
    ds_read_b64_tr_b16 v[118:119], v17 offset:4608
    s_waitcnt lgkmcnt(6)
    v_mfma_f32_32x32x16_bf16 v[64:79], v[104:107], a[4:7], v[64:79]
    ds_read_b64_tr_b16 v[96:97], v16 offset:6144
    ds_read_b64_tr_b16 v[98:99], v16 offset:6656
    s_waitcnt lgkmcnt(6)
    v_mfma_f32_32x32x16_bf16 v[80:95], v[108:111], a[4:7], v[80:95]
    ds_read_b64_tr_b16 v[100:101], v17 offset:6144
    ds_read_b64_tr_b16 v[102:103], v17 offset:6656
    s_waitcnt lgkmcnt(6)
    v_mfma_f32_32x32x16_bf16 v[64:79], v[112:115], a[8:11], v[64:79]
    ds_read_b64_tr_b16 v[104:105], v16 offset:8192
    ds_read_b64_tr_b16 v[106:107], v16 offset:8704
    s_waitcnt lgkmcnt(6)
    v_mfma_f32_32x32x16_bf16 v[80:95], v[116:119], a[8:11], v[80:95]
    ds_read_b64_tr_b16 v[108:109], v17 offset:8192
    ds_read_b64_tr_b16 v[110:111], v17 offset:8704
    s_waitcnt lgkmcnt(6)
    v_mfma_f32_32x32x16_bf16 v[64:79], v[96:99], a[12:15], v[64:79]
    ds_read_b64_tr_b16 v[112:113], v16 offset:10240
    ds_read_b64_tr_b16 v[114:115], v16 offset:10752
    s_waitcnt lgkmcnt(6)
    v_mfma_f32_32x32x16_bf16 v[80:95], v[100:103], a[12:15], v[80:95]
    ds_read_b64_tr_b16 v[116:117], v17 offset:10240
    ds_read_b64_tr_b16 v[118:119], v17 offset:10752
    s_waitcnt lgkmcnt(6)
    v_mfma_f32_32x32x16_bf16 v[64:79], v[104:107], a[16:19], v[64:79]
    ds_read_b64_tr_b16 v[96:97], v16 offset:12288
    ds_read_b64_tr_b16 v[98:99], v16 offset:12800
    s_waitcnt lgkmcnt(6)
    v_mfma_f32_32x32x16_bf16 v[80:95], v[108:111], a[16:19], v[80:95]
    ds_read_b64_tr_b16 v[100:101], v17 offset:12288
    ds_read_b64_tr_b16 v[102:103], v17 offset:12800
    s_waitcnt lgkmcnt(6)
    v_mfma_f32_32x32x16_bf16 v[64:79], v[112:115], a[20:23], v[64:79]
    ds_read_b64_tr_b16 v[104:105], v16 offset:14336
    ds_read_b64_tr_b16 v[106:107], v16 offset:14848
    s_waitcnt lgkmcnt(6)
    v_mfma_f32_32x32x16_bf16 v[80:95], v[116:119], a[20:23], v[80:95]
    ds_read_b64_tr_b16 v[108:109], v17 offset:14336
    ds_read_b64_tr_b16 v[110:111], v17 offset:14848
    s_waitcnt lgkmcnt(6)
    v_mfma_f32_32x32x16_bf16 v[64:79], v[96:99], a[24:27], v[64:79]
    ds_read_b64_tr_b16 v[112:113], v16 offset:16384
    ds_read_b64_tr_b16 v[114:115], v16 offset:16896
    s_waitcnt lgkmcnt(6)
    v_mfma_f32_32x32x16_bf16 v[80:95], v[100:103], a[24:27], v[80:95]
    ds_read_b64_tr_b16 v[116:117], v17 offset:16384
    ds_read_b64_tr_b16 v[118:119], v17 offset:16896
    s_waitcnt lgkmcnt(6)
    v_mfma_f32_32x32x16_bf16 v[64:79], v[104:107], a[28:31], v[64:79]
    ds_read_b64_tr_b16 v[96:97], v16 offset:18432
    ds_read_b64_tr_b16 v[98:99], v16 offset:18944
    s_waitcnt lgkmcnt(6)
    v_mfma_f32_32x32x16_bf16 v[80:95], v[108:111], a[28:31], v[80:95]
    ds_read_b64_tr_b16 v[100:101], v17 offset:18432
    ds_read_b64_tr_b16 v[102:103], v17 offset:18944
    s_waitcnt vmcnt(0)
    v_mov_b32 v29, 159768
    v_mov_b32 v30, 1
    s_mov_b64 exec, 1
    ds_add_u32 v29, v30
    s_mov_b64 exec, -1
    s_waitcnt lgkmcnt(7)
    v_mfma_f32_32x32x16_bf16 v[64:79], v[112:115], a[32:35], v[64:79]
    ds_read_b64_tr_b16 v[104:105], v16 offset:20480
    ds_read_b64_tr_b16 v[106:107], v16 offset:20992
    s_waitcnt lgkmcnt(7)
    v_mfma_f32_32x32x16_bf16 v[80:95], v[116:119], a[32:35], v[80:95]
    ds_read_b64_tr_b16 v[108:109], v17 offset:20480
    ds_read_b64_tr_b16 v[110:111], v17 offset:20992
    s_waitcnt lgkmcnt(7)
    v_mfma_f32_32x32x16_bf16 v[64:79], v[96:99], a[36:39], v[64:79]
    ds_read_b64_tr_b16 v[112:113], v16 offset:22528
    ds_read_b64_tr_b16 v[114:115], v16 offset:23040
    s_waitcnt lgkmcnt(7)
    v_mfma_f32_32x32x16_bf16 v[80:95], v[100:103], a[36:39], v[80:95]
    ds_read_b64_tr_b16 v[116:117], v17 offset:22528
    ds_read_b64_tr_b16 v[118:119], v17 offset:23040
    v_mov_b32 v29, 159768
    s_mov_b32 s79, 1280000
swb51:
    ds_read_b32 v30, v29
    s_waitcnt lgkmcnt(0)
    v_cmp_gt_u32 vcc, 4, v30
    s_cbranch_vccz swb51_ok
    s_sleep 1
    s_sub_u32 s79, s79, 1
    s_cbranch_scc0 swb51
swb51_ok:
    v_mov_b32 v29, 159792
    s_mov_b32 s79, 1280000
swb52:
    ds_read_b32 v30, v29
    s_waitcnt lgkmcnt(0)
    v_cmp_gt_u32 vcc, 4, v30
    s_cbranch_vccz swb52_ok
    s_sleep 1
    s_sub_u32 s79, s79, 1
    s_cbranch_scc0 swb52
swb52_ok:
    s_waitcnt lgkmcnt(6)
    v_mfma_f32_32x32x16_bf16 v[64:79], v[104:107], a[40:43], v[64:79]
    ds_read_b64_tr_b16 v[96:97], v16 offset:24576
    ds_read_b64_tr_b16 v[98:99], v16 offset:25088
    s_waitcnt lgkmcnt(6)
    v_mfma_f32_32x32x16_bf16 v[80:95], v[108:111], a[40:43], v[80:95]
    ds_read_b64_tr_b16 v[100:101], v17 offset:24576
    ds_read_b64_tr_b16 v[102:103], v17 offset:25088
    s_waitcnt lgkmcnt(6)
    v_mfma_f32_32x32x16_bf16 v[64:79], v[112:115], a[44:47], v[64:79]
    ds_read_b64_tr_b16 v[104:105], v16 offset:26624
    ds_read_b64_tr_b16 v[106:107], v16 offset:27136
    s_add_u32 m0, s21, 0
    s_nop 0
    buffer_load_dwordx4 v11, s[40:43], s82 offen lds
    s_add_u32 s82, s82, 7168
    s_waitcnt lgkmcnt(6)
    v_mfma_f32_32x32x16_bf16 v[80:95], v[116:119], a[44:47], v[80:95]
    ds_read_b64_tr_b16 v[108:109], v17 offset:26624
    ds_read_b64_tr_b16 v[110:111], v17 offset:27136
    s_waitcnt lgkmcnt(6)
    v_mfma_f32_32x32x16_bf16 v[64:79], v[96:99], a[48:51], v[64:79]
    ds_read_b64_tr_b16 v[112:113], v16 offset:28672
    ds_read_b64_tr_b16 v[114:115], v16 offset:29184
    s_waitcnt lgkmcnt(6)
    v_mfma_f32_32x32x16_bf16 v[80:95], v[100:103], a[48:51], v[80:95]
    ds_read_b64_tr_b16 v[116:117], v17 offset:28672
    ds_read_b64_tr_b16 v[118:119], v17 offset:29184
    s_add_u32 m0, s21, 1024
    s_nop 0
    buffer_load_dwordx4 v11, s[40:43], s82 offen lds
    s_add_u32 s82, s82, 107520
    s_waitcnt lgkmcnt(6)
    v_mfma_f32_32x32x16_bf16 v[64:79], v[104:107], a[52:55], v[64:79]
    ds_read_b64_tr_b16 v[96:97], v16 offset:30720
    ds_read_b64_tr_b16 v[98:99], v16 offset:31232
    s_waitcnt lgkmcnt(6)
    v_mfma_f32_32x32x16_bf16 v[80:95], v[108:111], a[52:55], v[80:95]
    ds_read_b64_tr_b16 v[100:101], v17 offset:30720
    ds_read_b64_tr_b16 v[102:103], v17 offset:31232
    s_add_u32 m0, s21, 8192
    s_nop 0
    buffer_load_dwordx4 v11, s[40:43], s82 offen lds
    s_add_u32 s82, s82, 7168
    s_waitcnt lgkmcnt(6)
    v_mfma_f32_32x32x16_bf16 v[64:79], v[112:115], a[56:59], v[64:79]
    ds_read_b64_tr_b16 v[104:105], v16 offset:32768
    ds_read_b64_tr_b16 v[106:107], v16 offset:33280
    s_waitcnt lgkmcnt(6)
    v_mfma_f32_32x32x16_bf16 v[80:95], v[116:119], a[56:59], v[80:95]
    ds_read_b64_tr_b16 v[108:109], v17 offset:32768
    ds_read_b64_tr_b16 v[110:111], v17 offset:33280
    s_waitcnt lgkmcnt(6)
    v_mfma_f32_32x32x16_bf16 v[64:79], v[96:99], a[60:63], v[64:79]
    ds_read_b64_tr_b16 v[112:113], v16 offset:34816
    ds_read_b64_tr_b16 v[114:115], v16 offset:35328
    s_add_u32 m0, s21, 9216
    s_nop 0
    buffer_load_dwordx4 v11, s[40:43], s82 offen lds
    s_add_u32 s82, s82, 107520
    s_waitcnt lgkmcnt(6)
    v_mfma_f32_32x32x16_bf16 v[80:95], v[100:103], a[60:63], v[80:95]
    ds_read_b64_tr_b16 v[116:117], v17 offset:34816
    ds_read_b64_tr_b16 v[118:119], v17 offset:35328
    s_waitcnt lgkmcnt(6)
    v_mfma_f32_32x32x16_bf16 v[64:79], v[104:107], v[128:131], v[64:79]
    ds_read_b64_tr_b16 v[96:97], v16 offset:36864
    ds_read_b64_tr_b16 v[98:99], v16 offset:37376
    s_add_u32 m0, s21, 16384
    s_nop 0
    buffer_load_dwordx4 v11, s[40:43], s82 offen lds
    s_add_u32 s82, s82, 7168
    s_waitcnt lgkmcnt(6)
    v_mfma_f32_32x32x16_bf16 v[80:95], v[108:111], v[128:131], v[80:95]
    ds_read_b64_tr_b16 v[100:101], v17 offset:36864
    ds_read_b64_tr_b16 v[102:103], v17 offset:37376
    s_waitcnt lgkmcnt(6)
    v_mfma_f32_32x32x16_bf16 v[64:79], v[112:115], v[132:135], v[64:79]
    ds_read_b64_tr_b16 v[104:105], v16 offset:38912
    ds_read_b64_tr_b16 v[106:107], v16 offset:39424
    s_waitcnt lgkmcnt(6)
    v_mfma_f32_32x32x16_bf16 v[80:95], v[116:119], v[132:135], v[80:95]
    ds_read_b64_tr_b16 v[108:109], v17 offset:38912
    ds_read_b64_tr_b16 v[110:111], v17 offset:39424
    s_add_u32 m0, s21, 17408
    s_nop 0
    buffer_load_dwordx4 v11, s[40:43], s82 offen lds
    s_add_u32 s82, s82, 107520
    s_waitcnt lgkmcnt(6)
    v_mfma_f32_32x32x16_bf16 v[64:79], v[96:99], v[136:139], v[64:79]
    ds_read_b64_tr_b16 v[112:113], v16 offset:40960
    ds_read_b64_tr_b16 v[114:115], v16 offset:41472
    s_waitcnt lgkmcnt(6)
    v_mfma_f32_32x32x16_bf16 v[80:95], v[100:103], v[136:139], v[80:95]
    ds_read_b64_tr_b16 v[116:117], v17 offset:40960
    ds_read_b64_tr_b16 v[118:119], v17 offset:41472
    s_add_u32 m0, s21, 24576
    s_nop 0
    buffer_load_dwordx4 v11, s[40:43], s82 offen lds
    s_add_u32 s82, s82, 7168
    s_waitcnt lgkmcnt(6)
    v_mfma_f32_32x32x16_bf16 v[64:79], v[104:107], v[140:143], v[64:79]
    ds_read_b64_tr_b16 v[96:97], v16 offset:43008
    ds_read_b64_tr_b16 v[98:99], v16 offset:43520
    s_waitcnt lgkmcnt(6)
    v_mfma_f32_32x32x16_bf16 v[80:95], v[108:111], v[140:143], v[80:95]
    ds_read_b64_tr_b16 v[100:101], v17 offset:43008
    ds_read_b64_tr_b16 v[102:103], v17 offset:43520
    s_waitcnt lgkmcnt(6)
    v_mfma_f32_32x32x16_bf16 v[64:79], v[112:115], v[144:147], v[64:79]
    ds_read_b64_tr_b16 v[104:105], v16 offset:45056
    ds_read_b64_tr_b16 v[106:107], v16 offset:45568
    s_add_u32 m0, s21, 25600
    s_nop 0
    buffer_load_dwordx4 v11, s[40:43], s82 offen lds
    s_add_u32 s82, s82, 107520
    s_waitcnt lgkmcnt(6)
    v_mfma_f32_32x32x16_bf16 v[80:95], v[116:119], v[144:147], v[80:95]
    ds_read_b64_tr_b16 v[108:109], v17 offset:45056
    ds_read_b64_tr_b16 v[110:111], v17 offset:45568
    s_waitcnt lgkmcnt(6)
    v_mfma_f32_32x32x16_bf16 v[64:79], v[96:99], v[148:151], v[64:79]
    ds_read_b64_tr_b16 v[112:113], v16 offset:47104
    ds_read_b64_tr_b16 v[114:115], v16 offset:47616
    s_waitcnt lgkmcnt(6)
    v_mfma_f32_32x32x16_bf16 v[80:95], v[100:103], v[148:151], v[80:95]
    ds_read_b64_tr_b16 v[116:117], v17 offset:47104
    ds_read_b64_tr_b16 v[118:119], v17 offset:47616
    s_add_u32 m0, s21, 32768
    s_nop 0
    buffer_load_dwordx4 v11, s[40:43], s82 offen lds
    s_add_u32 s82, s82, 7168
    s_waitcnt lgkmcnt(6)
    v_mfma_f32_32x32x16_bf16 v[64:79], v[104:107], v[152:155], v[64:79]
    ds_read_b64_tr_b16 v[96:97], v16 offset:49152
    ds_read_b64_tr_b16 v[98:99], v16 offset:49664
    s_waitcnt lgkmcnt(6)
    v_mfma_f32_32x32x16_bf16 v[80:95], v[108:111], v[152:155], v[80:95]
    ds_read_b64_tr_b16 v[100:101], v17 offset:49152
    ds_read_b64_tr_b16 v[102:103], v17 offset:49664
    s_add_u32 m0, s21, 33792
    s_nop 0
    buffer_load_dwordx4 v11, s[40:43], s82 offen lds
    s_add_u32 s82, s82, 107520
    s_waitcnt lgkmcnt(6)
    v_mfma_f32_32x32x16_bf16 v[64:79], v[112:115], v[156:159], v[64:79]
    ds_read_b64_tr_b16 v[104:105], v16 offset:51200
    ds_read_b64_tr_b16 v[106:107], v16 offset:51712
    s_waitcnt lgkmcnt(6)
    v_mfma_f32_32x32x16_bf16 v[80:95], v[116:119], v[156:159], v[80:95]
    ds_read_b64_tr_b16 v[108:109], v17 offset:51200
    ds_read_b64_tr_b16 v[110:111], v17 offset:51712
    s_waitcnt lgkmcnt(6)
    v_mfma_f32_32x32x16_bf16 v[64:79], v[96:99], v[160:163], v[64:79]
    ds_read_b64_tr_b16 v[112:113], v16 offset:53248
    ds_read_b64_tr_b16 v[114:115], v16 offset:53760
    s_add_u32 m0, s21, 40960
    s_nop 0
    buffer_load_dwordx4 v11, s[40:43], s82 offen lds
    s_add_u32 s82, s82, 7168
    s_waitcnt lgkmcnt(6)
    v_mfma_f32_32x32x16_bf16 v[80:95], v[100:103], v[160:163], v[80:95]
    ds_read_b64_tr_b16 v[116:117], v17 offset:53248
    ds_read_b64_tr_b16 v[118:119], v17 offset:53760
    s_waitcnt lgkmcnt(6)
    v_mfma_f32_32x32x16_bf16 v[64:79], v[104:107], v[164:167], v[64:79]
    ds_read_b64_tr_b16 v[96:97], v16 offset:55296
    ds_read_b64_tr_b16 v[98:99], v16 offset:55808
    s_add_u32 m0, s21, 41984
    s_nop 0
    buffer_load_dwordx4 v11, s[40:43], s82 offen lds
    s_add_u32 s82, s82, 107520
    s_waitcnt lgkmcnt(6)
    v_mfma_f32_32x32x16_bf16 v[80:95], v[108:111], v[164:167], v[80:95]
    ds_read_b64_tr_b16 v[100:101], v17 offset:55296
    ds_read_b64_tr_b16 v[102:103], v17 offset:55808
    s_waitcnt lgkmcnt(6)
    v_mfma_f32_32x32x16_bf16 v[64:79], v[112:115], v[168:171], v[64:79]
    s_waitcnt lgkmcnt(4)
    v_mfma_f32_32x32x16_bf16 v[80:95], v[116:119], v[168:171], v[80:95]
    s_add_u32 m0, s21, 49152
    s_nop 0
    buffer_load_dwordx4 v11, s[40:43], s82 offen lds
    s_add_u32 s82, s82, 7168
    s_waitcnt lgkmcnt(2)
    v_mfma_f32_32x32x16_bf16 v[64:79], v[96:99], v[172:175], v[64:79]
    s_waitcnt lgkmcnt(0)
    v_mfma_f32_32x32x16_bf16 v[80:95], v[100:103], v[172:175], v[80:95]
    s_add_u32 m0, s21, 50176
    s_nop 0
    buffer_load_dwordx4 v11, s[40:43], s82 offen lds
    s_sub_u32 s82, s82, 637952
    v_mov_b32 v29, 159752
    v_mov_b32 v30, 1
    s_mov_b64 exec, 1
    ds_add_u32 v29, v30
    s_mov_b64 exec, -1
    s_setprio 1
    v_pk_fma_f32 v[32:33], v[64:65], s[88:89], 1.0 op_sel_hi:[1,1,0]
    v_pk_fma_f32 v[34:35], v[66:67], s[88:89], 1.0 op_sel_hi:[1,1,0]
    v_pk_fma_f32 v[36:37], v[68:69], s[88:89], 1.0 op_sel_hi:[1,1,0]
    v_pk_fma_f32 v[38:39], v[70:71], s[88:89], 1.0 op_sel_hi:[1,1,0]
    v_exp_f32 v32, v32
    v_exp_f32 v33, v33
    v_exp_f32 v34, v34
    v_exp_f32 v35, v35
    v_exp_f32 v36, v36
    v_exp_f32 v37, v37
    v_exp_f32 v38, v38
    v_exp_f32 v39, v39
    v_pk_add_f32 v[32:33], v[32:33], 1.0 op_sel_hi:[1,0]
    v_pk_add_f32 v[34:35], v[34:35], 1.0 op_sel_hi:[1,0]
    v_pk_add_f32 v[36:37], v[36:37], 1.0 op_sel_hi:[1,0]
    v_pk_add_f32 v[38:39], v[38:39], 1.0 op_sel_hi:[1,0]
    v_pk_fma_f32 v[40:41], v[32:33], v[32:33], 1.0 op_sel_hi:[1,1,0]
    v_pk_fma_f32 v[42:43], v[34:35], v[34:35], 1.0 op_sel_hi:[1,1,0]
    v_pk_fma_f32 v[44:45], v[36:37], v[36:37], 1.0 op_sel_hi:[1,1,0]
    v_pk_fma_f32 v[46:47], v[38:39], v[38:39], 1.0 op_sel_hi:[1,1,0]
    v_rcp_f32 v40, v40
    v_rcp_f32 v41, v41
    v_rcp_f32 v42, v42
    v_rcp_f32 v43, v43
    v_rcp_f32 v44, v44
    v_rcp_f32 v45, v45
    v_rcp_f32 v46, v46
    v_rcp_f32 v47, v47
    v_pk_mul_f32 v[32:33], v[32:33], v[40:41] clamp
    v_pk_mul_f32 v[34:35], v[34:35], v[42:43] clamp
    v_pk_mul_f32 v[36:37], v[36:37], v[44:45] clamp
    v_pk_mul_f32 v[38:39], v[38:39], v[46:47] clamp
    v_pk_mul_f32 v[32:33], v[32:33], v[64:65]
    v_pk_mul_f32 v[34:35], v[34:35], v[66:67]
    v_pk_mul_f32 v[36:37], v[36:37], v[68:69]
    v_pk_mul_f32 v[38:39], v[38:39], v[70:71]
    v_cvt_pk_bf16_f32 v64, v32, v33
    v_cvt_pk_bf16_f32 v65, v34, v35
    v_cvt_pk_bf16_f32 v66, v36, v37
    v_cvt_pk_bf16_f32 v67, v38, v39
    s_cmp_eq_u32 s3, s23
    s_cbranch_scc1 L_df53
    buffer_store_dwordx4 v[64:67], v7, s[48:51], s84 offen offset:0 sc1
L_df53:
    v_pk_fma_f32 v[48:49], v[72:73], s[88:89], 1.0 op_sel_hi:[1,1,0]
    v_pk_fma_f32 v[50:51], v[74:75], s[88:89], 1.0 op_sel_hi:[1,1,0]
    v_pk_fma_f32 v[52:53], v[76:77], s[88:89], 1.0 op_sel_hi:[1,1,0]
    v_pk_fma_f32 v[54:55], v[78:79], s[88:89], 1.0 op_sel_hi:[1,1,0]
    v_exp_f32 v48, v48
    v_exp_f32 v49, v49
    v_exp_f32 v50, v50
    v_exp_f32 v51, v51
    v_exp_f32 v52, v52
    v_exp_f32 v53, v53
    v_exp_f32 v54, v54
    v_exp_f32 v55, v55
    v_pk_add_f32 v[48:49], v[48:49], 1.0 op_sel_hi:[1,0]
    v_pk_add_f32 v[50:51], v[50:51], 1.0 op_sel_hi:[1,0]
    v_pk_add_f32 v[52:53], v[52:53], 1.0 op_sel_hi:[1,0]
    v_pk_add_f32 v[54:55], v[54:55], 1.0 op_sel_hi:[1,0]
    v_pk_fma_f32 v[56:57], v[48:49], v[48:49], 1.0 op_sel_hi:[1,1,0]
    v_pk_fma_f32 v[58:59], v[50:51], v[50:51], 1.0 op_sel_hi:[1,1,0]
    v_pk_fma_f32 v[60:61], v[52:53], v[52:53], 1.0 op_sel_hi:[1,1,0]
    v_pk_fma_f32 v[62:63], v[54:55], v[54:55], 1.0 op_sel_hi:[1,1,0]
    v_rcp_f32 v56, v56
    v_rcp_f32 v57, v57
    v_rcp_f32 v58, v58
    v_rcp_f32 v59, v59
    v_rcp_f32 v60, v60
    v_rcp_f32 v61, v61
    v_rcp_f32 v62, v62
    v_rcp_f32 v63, v63
    v_pk_mul_f32 v[48:49], v[48:49], v[56:57] clamp
    v_pk_mul_f32 v[50:51], v[50:51], v[58:59] clamp
    v_pk_mul_f32 v[52:53], v[52:53], v[60:61] clamp
    v_pk_mul_f32 v[54:55], v[54:55], v[62:63] clamp
    v_pk_mul_f32 v[48:49], v[48:49], v[72:73]
    v_pk_mul_f32 v[50:51], v[50:51], v[74:75]
    v_pk_mul_f32 v[52:53], v[52:53], v[76:77]
    v_pk_mul_f32 v[54:55], v[54:55], v[78:79]
    v_cvt_pk_bf16_f32 v72, v48, v49
    v_cvt_pk_bf16_f32 v73, v50, v51
    v_cvt_pk_bf16_f32 v74, v52, v53
    v_cvt_pk_bf16_f32 v75, v54, v55
    s_cmp_eq_u32 s3, s23
    s_cbranch_scc1 L_df54
    buffer_store_dwordx4 v[72:75], v7, s[48:51], s84 offen offset:1024 sc1
L_df54:
    v_pk_fma_f32 v[32:33], v[80:81], s[88:89], 1.0 op_sel_hi:[1,1,0]
    v_pk_fma_f32 v[34:35], v[82:83], s[88:89], 1.0 op_sel_hi:[1,1,0]
    v_pk_fma_f32 v[36:37], v[84:85], s[88:89], 1.0 op_sel_hi:[1,1,0]
    v_pk_fma_f32 v[38:39], v[86:87], s[88:89], 1.0 op_sel_hi:[1,1,0]
    v_exp_f32 v32, v32
    v_exp_f32 v33, v33
    v_exp_f32 v34, v34
    v_exp_f32 v35, v35
    v_exp_f32 v36, v36
    v_exp_f32 v37, v37
    v_exp_f32 v38, v38
    v_exp_f32 v39, v39
    v_pk_add_f32 v[32:33], v[32:33], 1.0 op_sel_hi:[1,0]
    v_pk_add_f32 v[34:35], v[34:35], 1.0 op_sel_hi:[1,0]
    v_pk_add_f32 v[36:37], v[36:37], 1.0 op_sel_hi:[1,0]
    v_pk_add_f32 v[38:39], v[38:39], 1.0 op_sel_hi:[1,0]
    v_pk_fma_f32 v[40:41], v[32:33], v[32:33], 1.0 op_sel_hi:[1,1,0]
    v_pk_fma_f32 v[42:43], v[34:35], v[34:35], 1.0 op_sel_hi:[1,1,0]
    v_pk_fma_f32 v[44:45], v[36:37], v[36:37], 1.0 op_sel_hi:[1,1,0]
    v_pk_fma_f32 v[46:47], v[38:39], v[38:39], 1.0 op_sel_hi:[1,1,0]
    v_rcp_f32 v40, v40
    v_rcp_f32 v41, v41
    v_rcp_f32 v42, v42
    v_rcp_f32 v43, v43
    v_rcp_f32 v44, v44
    v_rcp_f32 v45, v45
    v_rcp_f32 v46, v46
    v_rcp_f32 v47, v47
    v_pk_mul_f32 v[32:33], v[32:33], v[40:41] clamp
    v_pk_mul_f32 v[34:35], v[34:35], v[42:43] clamp
    v_pk_mul_f32 v[36:37], v[36:37], v[44:45] clamp
    v_pk_mul_f32 v[38:39], v[38:39], v[46:47] clamp
    v_pk_mul_f32 v[32:33], v[32:33], v[80:81]
    v_pk_mul_f32 v[34:35], v[34:35], v[82:83]
    v_pk_mul_f32 v[36:37], v[36:37], v[84:85]
    v_pk_mul_f32 v[38:39], v[38:39], v[86:87]
    v_cvt_pk_bf16_f32 v80, v32, v33
    v_cvt_pk_bf16_f32 v81, v34, v35
    v_cvt_pk_bf16_f32 v82, v36, v37
    v_cvt_pk_bf16_f32 v83, v38, v39
    s_cmp_eq_u32 s3, s23
    s_cbranch_scc1 L_df55
    buffer_store_dwordx4 v[80:83], v7, s[48:51], s84 offen offset:2048 sc1
L_df55:
    v_pk_fma_f32 v[48:49], v[88:89], s[88:89], 1.0 op_sel_hi:[1,1,0]
    v_pk_fma_f32 v[50:51], v[90:91], s[88:89], 1.0 op_sel_hi:[1,1,0]
    v_pk_fma_f32 v[52:53], v[92:93], s[88:89], 1.0 op_sel_hi:[1,1,0]
    v_pk_fma_f32 v[54:55], v[94:95], s[88:89], 1.0 op_sel_hi:[1,1,0]
    v_exp_f32 v48, v48
    v_exp_f32 v49, v49
    v_exp_f32 v50, v50
    v_exp_f32 v51, v51
    v_exp_f32 v52, v52
    v_exp_f32 v53, v53
    v_exp_f32 v54, v54
    v_exp_f32 v55, v55
    v_pk_add_f32 v[48:49], v[48:49], 1.0 op_sel_hi:[1,0]
    v_pk_add_f32 v[50:51], v[50:51], 1.0 op_sel_hi:[1,0]
    v_pk_add_f32 v[52:53], v[52:53], 1.0 op_sel_hi:[1,0]
    v_pk_add_f32 v[54:55], v[54:55], 1.0 op_sel_hi:[1,0]
    v_pk_fma_f32 v[56:57], v[48:49], v[48:49], 1.0 op_sel_hi:[1,1,0]
    v_pk_fma_f32 v[58:59], v[50:51], v[50:51], 1.0 op_sel_hi:[1,1,0]
    v_pk_fma_f32 v[60:61], v[52:53], v[52:53], 1.0 op_sel_hi:[1,1,0]
    v_pk_fma_f32 v[62:63], v[54:55], v[54:55], 1.0 op_sel_hi:[1,1,0]
    v_rcp_f32 v56, v56
    v_rcp_f32 v57, v57
    v_rcp_f32 v58, v58
    v_rcp_f32 v59, v59
    v_rcp_f32 v60, v60
    v_rcp_f32 v61, v61
    v_rcp_f32 v62, v62
    v_rcp_f32 v63, v63
    v_pk_mul_f32 v[48:49], v[48:49], v[56:57] clamp
    v_pk_mul_f32 v[50:51], v[50:51], v[58:59] clamp
    v_pk_mul_f32 v[52:53], v[52:53], v[60:61] clamp
    v_pk_mul_f32 v[54:55], v[54:55], v[62:63] clamp
    v_pk_mul_f32 v[48:49], v[48:49], v[88:89]
    v_pk_mul_f32 v[50:51], v[50:51], v[90:91]
    v_pk_mul_f32 v[52:53], v[52:53], v[92:93]
    v_pk_mul_f32 v[54:55], v[54:55], v[94:95]
    v_cvt_pk_bf16_f32 v88, v48, v49
    v_cvt_pk_bf16_f32 v89, v50, v51
    v_cvt_pk_bf16_f32 v90, v52, v53
    v_cvt_pk_bf16_f32 v91, v54, v55
    s_cmp_eq_u32 s3, s23
    s_cbranch_scc1 L_df56
    buffer_store_dwordx4 v[88:91], v7, s[48:51], s84 offen offset:3072 sc1
L_df56:
    s_setprio 0
    s_lshl_b32 s73, s86, 6
    s_lshl_b32 s72, s64, 3
    s_add_u32 s72, s72, s73
    v_lshrrev_b32 v13, 3, v1
    v_add_u32 v13, s72, v13
    v_lshlrev_b32 v15, 2, v13
    v_bfe_u32 v12, v13, 2, 4
    v_bfe_u32 v14, v13, 8, 1
    v_lshl_add_u32 v12, v14, 4, v12
    v_and_b32 v14, 3, v13
    v_lshl_add_u32 v12, v14, 5, v12
    v_and_b32 v14, 0xc0, v13
    v_lshl_add_u32 v12, v14, 1, v12
    v_and_b32 v14, 0x600, v13
    v_add_u32 v12, v12, v14
    v_mul_u32_u24 v12, 896, v12
    v_and_b32 v14, 7, v1
    v_lshl_add_u32 v12, v14, 4, v12
    v_and_b32 v13, 31, v13
    v_and_b32 v17, 3, v1
    v_lshlrev_b32 v17, 2, v17
    v_xor_b32 v16, v13, v17
    v_lshlrev_b32 v16, 4, v16
    v_lshl_add_u32 v16, v14, 10, v16
    s_lshl_b32 s72, s81, 13
    v_add_u32 v16, s72, v16
    v_and_b32 v22, 0xfff, v16
    v_bfe_u32 v14, v1, 2, 1
    v_mul_u32_u24 v14, 14336, v14
    s_lshl_b32 s72, s81, 12
    v_add3_u32 v22, v22, v14, s72
    s_cmp_lg_u32 s3, s23
    s_cbranch_scc1 L_df2
    buffer_store_dwordx4 v[64:67], v7, s[48:51], s84 offen offset:0 sc1
    buffer_store_dwordx4 v[72:75], v7, s[48:51], s84 offen offset:1024 sc1
    buffer_store_dwordx4 v[80:83], v7, s[48:51], s84 offen offset:2048 sc1
    buffer_store_dwordx4 v[88:91], v7, s[48:51], s84 offen offset:3072 sc1
L_df2:
    s_mul_i32 s73, s23, 7
    s_lshl_b32 s20, s91, 5
    s_add_u32 s20, s20, s73
    s_mul_i32 s73, s3, 3
    s_add_u32 s20, s20, s73
    s_lshl_b32 s20, s20, 2
    s_lshr_b32 s73, s20, 6
    s_mul_i32 s73, s73, 64
    s_add_u32 s20, s20, s73
    s_add_u32 s20, s20, 16384
    s_mul_i32 s84, s91, 57
    s_mul_i32 s73, s23, 28
    s_add_u32 s84, s84, s73
    s_mul_i32 s73, s3, 14
    s_add_u32 s84, s84, s73
    s_lshl_b32 s84, s84, 10
    s_add_u32 s84, s84, 8388608
    s_mov_b32 s85, 0
    v_mov_b32 v29, 159792
    s_mov_b32 s79, 1280000
swb57:
    ds_read_b32 v30, v29
    s_waitcnt lgkmcnt(0)
    v_cmp_gt_u32 vcc, 4, v30
    s_cbranch_vccz swb57_ok
    s_sleep 1
    s_sub_u32 s79, s79, 1
    s_cbranch_scc0 swb57
swb57_ok:
    v_mov_b32 v29, 159752
    s_mov_b32 s79, 1280000
swb58:
    ds_read_b32 v30, v29
    s_waitcnt lgkmcnt(0)
    v_cmp_gt_u32 vcc, 4, v30
    s_cbranch_vccz swb58_ok
    s_sleep 1
    s_sub_u32 s79, s79, 1
    s_cbranch_scc0 swb58
swb58_ok:
    s_waitcnt vmcnt(4)
    v_mov_b32 v29, 159760
    v_mov_b32 v30, 1
    s_mov_b64 exec, 1
    ds_add_u32 v29, v30
    s_mov_b64 exec, -1
    s_xor_b32 s72, s80, 0
    s_mul_i32 s72, s72, 56
    v_lshl_add_u32 v43, v3, 2, s72
    v_cvt_f32_u32 v43, v43
    s_and_b32 s72, s80, 1
    s_lshl_b32 s72, s72, 5
    v_add_u32 v40, s72, v2
    s_lshl_b32 s72, s66, 6
    v_add_u32 v40, s72, v40
    v_cvt_f32_u32 v40, v40
    v_mul_f32 v40, 0xbb124925, v40
    v_mul_f32 v41, v40, v43
    v_mul_f32 v42, 0x41000000, v40
    v_cos_f32 v42, v42
    v_mov_b32 v48, v41
    v_add_f32 v49, v40, v41
    v_fmamk_f32 v50, v40, 0x40000000, v41
    v_fmamk_f32 v51, v40, 0x40400000, v41
    v_cos_f32 v44, v48
    v_sin_f32 v48, v48
    v_cos_f32 v45, v49
    v_sin_f32 v49, v49
    v_cos_f32 v46, v50
    v_sin_f32 v50, v50
    v_cos_f32 v47, v51
    v_sin_f32 v51, v51
    v_add_f32 v42, v42, v42
    v_cvt_pk_bf16_f32 v128, v44, v48
    v_cvt_pk_bf16_f32 v129, v45, v49
    v_cvt_pk_bf16_f32 v130, v46, v50
    v_cvt_pk_bf16_f32 v131, v47, v51
    v_fmamk_f32 v56, v40, 0x41000000, v41
    v_fmamk_f32 v57, v40, 0x41100000, v41
    v_fmamk_f32 v58, v40, 0x41200000, v41
    v_fmamk_f32 v59, v40, 0x41300000, v41
    v_cos_f32 v52, v56
    v_sin_f32 v56, v56
    v_cos_f32 v53, v57
    v_sin_f32 v57, v57
    v_cos_f32 v54, v58
    v_sin_f32 v58, v58
    v_cos_f32 v55, v59
    v_sin_f32 v59, v59
    v_cvt_pk_bf16_f32 v132, v52, v56
    v_cvt_pk_bf16_f32 v133, v53, v57
    s_cmp_lg_u32 s85, 0
    s_cbranch_scc1 L_ts59
    s_getreg_b32 s72, hwreg(HW_REG_IB_STS)
    s_and_b32 s72, s72, 0xc000000f
    s_cmp_gt_u32 s72, 0
    s_cbranch_scc1 L_ts59
    s_waitcnt vmcnt(0)
    v_mov_b32 v26, s71
    s_mov_b64 exec, 1
    buffer_store_dword v26, v7, s[48:51], s77 offen sc1
    s_mov_b64 exec, -1
    s_mov_b32 s85, 1
L_ts59:
    v_cvt_pk_bf16_f32 v134, v54, v58
    v_cvt_pk_bf16_f32 v135, v55, v59
    v_fma_f32 v44, v42, v52, -v44
    v_fma_f32 v45, v42, v53, -v45
    v_fma_f32 v46, v42, v54, -v46
    v_fma_f32 v47, v42, v55, -v47
    v_fma_f32 v48, v42, v56, -v48
    v_fma_f32 v49, v42, v57, -v49
    v_fma_f32 v50, v42, v58, -v50
    v_fma_f32 v51, v42, v59, -v51
    v_cvt_pk_bf16_f32 v136, v44, v48
    v_cvt_pk_bf16_f32 v137, v45, v49
    v_cvt_pk_bf16_f32 v138, v46, v50
    v_cvt_pk_bf16_f32 v139, v47, v51
    v_fma_f32 v52, v42, v44, -v52
    v_fma_f32 v53, v42, v45, -v53
    v_fma_f32 v54, v42, v46, -v54
    v_fma_f32 v55, v42, v47, -v55
    v_fma_f32 v56, v42, v48, -v56
    v_fma_f32 v57, v42, v49, -v57
    v_fma_f32 v58, v42, v50, -v58
    v_fma_f32 v59, v42, v51, -v59
    v_cvt_pk_bf16_f32 v140, v52, v56
    v_cvt_pk_bf16_f32 v141, v53, v57
    v_cvt_pk_bf16_f32 v142, v54, v58
    v_cvt_pk_bf16_f32 v143, v55, v59
    v_fma_f32 v44, v42, v52, -v44
    v_fma_f32 v45, v42, v53, -v45
    v_fma_f32 v46, v42, v54, -v46
    v_fma_f32 v47, v42, v55, -v47
    v_fma_f32 v48, v42, v56, -v48
    v_fma_f32 v49, v42, v57, -v49
    v_fma_f32 v50, v42, v58, -v50
    v_fma_f32 v51, v42, v59, -v51
    v_cvt_pk_bf16_f32 v144, v44, v48
    v_cvt_pk_bf16_f32 v145, v45, v49
    v_cvt_pk_bf16_f32 v146, v46, v50
    v_cvt_pk_bf16_f32 v147, v47, v51
    v_fma_f32 v52, v42, v44, -v52
    v_fma_f32 v53, v42, v45, -v53
    s_cmp_lg_u32 s85, 0
    s_cbranch_scc1 L_ts60
    s_getreg_b32 s72, hwreg(HW_REG_IB_STS)
    s_and_b32 s72, s72, 0xc000000f
    s_cmp_gt_u32 s72, 0
    s_cbranch_scc1 L_ts60
    s_waitcnt vmcnt(0)
    v_mov_b32 v26, s71
    s_mov_b64 exec, 1
    buffer_store_dword v26, v7, s[48:51], s77 offen sc1
    s_mov_b64 exec, -1
    s_mov_b32 s85, 1
L_ts60:
    v_fma_f32 v54, v42, v46, -v54
    v_fma_f32 v55, v42, v47, -v55
    v_fma_f32 v56, v42, v48, -v56
    v_fma_f32 v57, v42, v49, -v57
    v_fma_f32 v58, v42, v50, -v58
    v_fma_f32 v59, v42, v51, -v59
    v_cvt_pk_bf16_f32 v148, v52, v56
    v_cvt_pk_bf16_f32 v149, v53, v57
    v_cvt_pk_bf16_f32 v150, v54, v58
    v_cvt_pk_bf16_f32 v151, v55, v59
    v_fma_f32 v44, v42, v52, -v44
    v_fma_f32 v45, v42, v53, -v45
    v_fma_f32 v46, v42, v54, -v46
    v_fma_f32 v47, v42, v55, -v47
    v_fma_f32 v48, v42, v56, -v48
    v_fma_f32 v49, v42, v57, -v49
    v_fma_f32 v50, v42, v58, -v50
    v_fma_f32 v51, v42, v59, -v51
    v_cvt_pk_bf16_f32 v152, v44, v48
    v_cvt_pk_bf16_f32 v153, v45, v49
    v_cvt_pk_bf16_f32 v154, v46, v50
    v_cvt_pk_bf16_f32 v155, v47, v51
    v_fma_f32 v52, v42, v44, -v52
    v_fma_f32 v53, v42, v45, -v53
    v_fma_f32 v54, v42, v46, -v54
    v_fma_f32 v55, v42, v47, -v55
    v_fma_f32 v56, v42, v48, -v56
    v_fma_f32 v57, v42, v49, -v57
    v_fma_f32 v58, v42, v50, -v58
    v_fma_f32 v59, v42, v51, -v59
    v_cvt_pk_bf16_f32 v156, v52, v56
    v_cvt_pk_bf16_f32 v157, v53, v57
    v_cvt_pk_bf16_f32 v158, v54, v58
    v_cvt_pk_bf16_f32 v159, v55, v59
    s_xor_b32 s72, s80, 1
    s_mul_i32 s72, s72, 56
    v_lshl_add_u32 v43, v3, 2, s72
    v_cvt_f32_u32 v43, v43
    s_and_b32 s72, s80, 1
    s_lshl_b32 s72, s72, 5
    v_add_u32 v40, s72, v2
    s_lshl_b32 s72, s66, 6
    v_add_u32 v40, s72, v40
    v_cvt_f32_u32 v40, v40
    v_mul_f32 v40, 0xbb124925, v40
    s_cmp_lg_u32 s85, 0
    s_cbranch_scc1 L_ts61
    s_getreg_b32 s72, hwreg(HW_REG_IB_STS)
    s_and_b32 s72, s72, 0xc000000f
    s_cmp_gt_u32 s72, 0
    s_cbranch_scc1 L_ts61
    s_waitcnt vmcnt(0)
    v_mov_b32 v26, s71
    s_mov_b64 exec, 1
    buffer_store_dword v26, v7, s[48:51], s77 offen sc1
    s_mov_b64 exec, -1
    s_mov_b32 s85, 1
L_ts61:
    v_mul_f32 v41, v40, v43
    v_mul_f32 v42, 0x41000000, v40
    v_cos_f32 v42, v42
    v_mov_b32 v48, v41
    v_add_f32 v49, v40, v41
    v_fmamk_f32 v50, v40, 0x40000000, v41
    v_fmamk_f32 v51, v40, 0x40400000, v41
    v_cos_f32 v44, v48
    v_sin_f32 v48, v48
    v_cos_f32 v45, v49
    v_sin_f32 v49, v49
    v_cos_f32 v46, v50
    v_sin_f32 v50, v50
    v_cos_f32 v47, v51
    v_sin_f32 v51, v51
    v_add_f32 v42, v42, v42
    v_cvt_pk_bf16_f32 v160, v44, v48
    v_cvt_pk_bf16_f32 v161, v45, v49
    v_cvt_pk_bf16_f32 v162, v46, v50
    v_cvt_pk_bf16_f32 v163, v47, v51
    v_fmamk_f32 v56, v40, 0x41000000, v41
    v_fmamk_f32 v57, v40, 0x41100000, v41
    v_fmamk_f32 v58, v40, 0x41200000, v41
    v_fmamk_f32 v59, v40, 0x41300000, v41
    v_cos_f32 v52, v56
    v_sin_f32 v56, v56
    v_cos_f32 v53, v57
    v_sin_f32 v57, v57
    v_cos_f32 v54, v58
    v_sin_f32 v58, v58
    v_cos_f32 v55, v59
    v_sin_f32 v59, v59
    v_cvt_pk_bf16_f32 v164, v52, v56
    v_cvt_pk_bf16_f32 v165, v53, v57
    v_cvt_pk_bf16_f32 v166, v54, v58
    v_cvt_pk_bf16_f32 v167, v55, v59
    v_fma_f32 v44, v42, v52, -v44
    v_fma_f32 v45, v42, v53, -v45
    v_fma_f32 v46, v42, v54, -v46
    v_fma_f32 v47, v42, v55, -v47
    s_cmp_lg_u32 s85, 0
    s_cbranch_scc1 L_ts62
    s_getreg_b32 s72, hwreg(HW_REG_IB_STS)
    s_and_b32 s72, s72, 0xc000000f
    s_cmp_gt_u32 s72, 0
    s_cbranch_scc1 L_ts62
    s_waitcnt vmcnt(0)
    v_mov_b32 v26, s71
    s_mov_b64 exec, 1
    buffer_store_dword v26, v7, s[48:51], s77 offen sc1
    s_mov_b64 exec, -1
    s_mov_b32 s85, 1
L_ts62:
    v_fma_f32 v48, v42, v56, -v48
    v_fma_f32 v49, v42, v57, -v49
    v_fma_f32 v50, v42, v58, -v50
    v_fma_f32 v51, v42, v59, -v51
    v_cvt_pk_bf16_f32 v168, v44, v48
    v_cvt_pk_bf16_f32 v169, v45, v49
    v_cvt_pk_bf16_f32 v170, v46, v50
    v_cvt_pk_bf16_f32 v171, v47, v51
    v_fma_f32 v52, v42, v44, -v52
    v_fma_f32 v53, v42, v45, -v53
    v_fma_f32 v54, v42, v46, -v54
    v_fma_f32 v55, v42, v47, -v55
    v_fma_f32 v56, v42, v48, -v56
    v_fma_f32 v57, v42, v49, -v57
    v_fma_f32 v58, v42, v50, -v58
    v_fma_f32 v59, v42, v51, -v59
    v_cvt_pk_bf16_f32 v172, v52, v56
    v_cvt_pk_bf16_f32 v173, v53, v57
    v_cvt_pk_bf16_f32 v174, v54, v58
    v_cvt_pk_bf16_f32 v175, v55, v59
    v_fma_f32 v44, v42, v52, -v44
    v_fma_f32 v45, v42, v53, -v45
    v_fma_f32 v46, v42, v54, -v46
    v_fma_f32 v47, v42, v55, -v47
    v_fma_f32 v48, v42, v56, -v48
    v_fma_f32 v49, v42, v57, -v49
    v_fma_f32 v50, v42, v58, -v50
    v_fma_f32 v51, v42, v59, -v51
    v_cvt_pk_bf16_f32 v176, v44, v48
    v_cvt_pk_bf16_f32 v177, v45, v49
    v_cvt_pk_bf16_f32 v178, v46, v50
    v_cvt_pk_bf16_f32 v179, v47, v51
    v_fma_f32 v52, v42, v44, -v52
    v_fma_f32 v53, v42, v45, -v53
    v_fma_f32 v54, v42, v46, -v54
    v_fma_f32 v55, v42, v47, -v55
    v_fma_f32 v56, v42, v48, -v56
    v_fma_f32 v57, v42, v49, -v57
    v_fma_f32 v58, v42, v50, -v58
    v_fma_f32 v59, v42, v51, -v59
    s_cmp_lg_u32 s85, 0
    s_cbranch_scc1 L_ts63
    s_getreg_b32 s72, hwreg(HW_REG_IB_STS)
    s_and_b32 s72, s72, 0xc000000f
    s_cmp_gt_u32 s72, 0
    s_cbranch_scc1 L_ts63
    s_waitcnt vmcnt(0)
    v_mov_b32 v26, s71
    s_mov_b64 exec, 1
    buffer_store_dword v26, v7, s[48:51], s77 offen sc1
    s_mov_b64 exec, -1
    s_mov_b32 s85, 1
L_ts63:
    s_cmp_lg_u32 s85, 0
    s_cbranch_scc1 L_ts64
    s_waitcnt vmcnt(0)
    v_mov_b32 v26, s71
    s_mov_b64 exec, 1
    buffer_store_dword v26, v7, s[48:51], s77 offen sc1
    s_mov_b64 exec, -1
    s_mov_b32 s85, 1
L_ts64:
    s_add_u32 s98, s20, 128
    s_load_dwordx4 s[4:7], s[24:25], s20 glc
    s_load_dwordx4 s[8:11], s[24:25], s98 glc
    s_add_u32 m0, s21, 65536
    s_nop 0
    buffer_load_dwordx4 v11, s[40:43], s82 offen lds
    s_add_u32 s82, s82, 7168
    s_add_u32 m0, s21, 66560
    s_nop 0
    buffer_load_dwordx4 v11, s[40:43], s82 offen lds
    s_add_u32 s82, s82, 107520
    s_add_u32 m0, s21, 73728
    s_nop 0
    buffer_load_dwordx4 v11, s[40:43], s82 offen lds
    s_add_u32 s82, s82, 7168
    s_add_u32 m0, s21, 74752
    s_nop 0
    buffer_load_dwordx4 v11, s[40:43], s82 offen lds
    s_add_u32 s82, s82, 107520
    s_add_u32 m0, s21, 81920
    s_nop 0
    buffer_load_dwordx4 v11, s[40:43], s82 offen lds
    s_add_u32 s82, s82, 7168
    s_add_u32 m0, s21, 82944
    s_nop 0
    buffer_load_dwordx4 v11, s[40:43], s82 offen lds
    s_add_u32 s82, s82, 107520
    s_add_u32 m0, s21, 90112
    s_nop 0
    buffer_load_dwordx4 v11, s[40:43], s82 offen lds
    s_add_u32 s82, s82, 7168
    s_add_u32 m0, s21, 91136
    s_nop 0
    buffer_load_dwordx4 v11, s[40:43], s82 offen lds
    s_add_u32 s82, s82, 107520
    s_add_u32 m0, s21, 98304
    s_nop 0
    buffer_load_dwordx4 v11, s[40:43], s82 offen lds
    s_add_u32 s82, s82, 7168
    s_add_u32 m0, s21, 99328
    s_nop 0
    buffer_load_dwordx4 v11, s[40:43], s82 offen lds
    s_add_u32 s82, s82, 107520
    s_add_u32 m0, s21, 106496
    s_nop 0
    buffer_load_dwordx4 v11, s[40:43], s82 offen lds
    s_add_u32 s82, s82, 7168
    s_add_u32 m0, s21, 107520
    s_nop 0
    buffer_load_dwordx4 v11, s[40:43], s82 offen lds
    s_add_u32 s82, s82, 107520
    s_add_u32 m0, s21, 114688
    s_nop 0
    buffer_load_dwordx4 v11, s[40:43], s82 offen lds
    s_add_u32 s82, s82, 7168
    s_add_u32 m0, s21, 115712
    s_nop 0
    buffer_load_dwordx4 v11, s[40:43], s82 offen lds
    s_sub_u32 s82, s82, 637952
    v_cvt_pk_bf16_f32 v180, v52, v56
    v_cvt_pk_bf16_f32 v181, v53, v57
    v_cvt_pk_bf16_f32 v182, v54, v58
    v_cvt_pk_bf16_f32 v183, v55, v59
    v_fma_f32 v44, v42, v52, -v44
    v_fma_f32 v45, v42, v53, -v45
    v_fma_f32 v46, v42, v54, -v46
    v_fma_f32 v47, v42, v55, -v47
    v_fma_f32 v48, v42, v56, -v48
    v_fma_f32 v49, v42, v57, -v49
    v_fma_f32 v50, v42, v58, -v50
    v_fma_f32 v51, v42, v59, -v51
    v_cvt_pk_bf16_f32 v184, v44, v48
    v_cvt_pk_bf16_f32 v185, v45, v49
    v_cvt_pk_bf16_f32 v186, v46, v50
    v_cvt_pk_bf16_f32 v187, v47, v51
    v_fma_f32 v52, v42, v44, -v52
    v_fma_f32 v53, v42, v45, -v53
    v_fma_f32 v54, v42, v46, -v54
    v_fma_f32 v55, v42, v47, -v55
    v_fma_f32 v56, v42, v48, -v56
    v_fma_f32 v57, v42, v49, -v57
    v_fma_f32 v58, v42, v50, -v58
    v_fma_f32 v59, v42, v51, -v59
    v_cvt_pk_bf16_f32 v188, v52, v56
    v_cvt_pk_bf16_f32 v189, v53, v57
    v_cvt_pk_bf16_f32 v190, v54, v58
    v_cvt_pk_bf16_f32 v191, v55, v59
    s_mul_i32 s73, s80, 56
    v_min_u32 v8, 56, v1
    v_add_u32 v8, s73, v8
    s_lshr_b32 s73, s86, 3
    s_lshl_b32 s73, s73, 8
    v_add_u32 v8, s73, v8
    v_mul_u32_u24 v8, 16, v8
    v_lshrrev_b32 v9, 7, v8
    v_mul_u32_u24 v9, 0, v9
    v_add_u32 v8, v8, v9
    v_add_u32 v8, 32768, v8
    s_setprio 1
    s_branch L_go3
L_side:
    s_sub_u32 s68, s2, 224
    s_cmp_lg_u32 s81, 0
    s_cbranch_scc1 L_gate
    s_and_b32 s72, s68, 7
    s_lshl_b32 s72, s72, 2
    s_add_u32 s72, s72, s80
    s_lshl_b32 s72, s72, 2
    s_lshr_b32 s73, s68, 3
    s_add_u32 s72, s72, s73
    s_mul_i32 s75, s72, 7200
    s_add_u32 s73, s75, 4096
    s_lshl_b32 s72, s80, 13
    s_waitcnt lgkmcnt(0)
    s_mov_b32 s56, s6
    s_mov_b32 s57, s7
    s_mov_b32 s58, 921600
    s_mov_b32 s59, 0x00020000
    s_mov_b32 s60, s8
    s_mov_b32 s61, s9
    s_mov_b32 s62, 921600
    s_mov_b32 s63, 0x00020000
    s_add_u32 m0, s72, 0
    s_nop 0
    buffer_load_dwordx4 v7, s[56:59], s75 offen offset:0 lds
    buffer_load_dwordx4 v7, s[56:59], s75 offen offset:1024 lds
    buffer_load_dwordx4 v7, s[56:59], s75 offen offset:2048 lds
    buffer_load_dwordx4 v7, s[56:59], s75 offen offset:3072 lds
    s_mov_b64 exec, -1
    s_add_u32 m0, s72, 4096
    s_nop 0
    buffer_load_dwordx4 v7, s[56:59], s73 offen offset:0 lds
    buffer_load_dwordx4 v7, s[56:59], s73 offen offset:1024 lds
    buffer_load_dwordx4 v7, s[56:59], s73 offen offset:2048 lds
    s_mov_b64 exec, 3
    buffer_load_dwordx4 v7, s[56:59], s73 offen offset:3072 lds
    s_mov_b64 exec, -1
    s_add_u32 m0, s72, 32768
    s_nop 0
    buffer_load_dwordx4 v7, s[60:63], s75 offen offset:0 lds
    buffer_load_dwordx4 v7, s[60:63], s75 offen offset:1024 lds
    buffer_load_dwordx4 v7, s[60:63], s75 offen offset:2048 lds
    buffer_load_dwordx4 v7, s[60:63], s75 offen offset:3072 lds
    s_mov_b64 exec, -1
    s_add_u32 m0, s72, 36864
    s_nop 0
    buffer_load_dwordx4 v7, s[60:63], s73 offen offset:0 lds
    buffer_load_dwordx4 v7, s[60:63], s73 offen offset:1024 lds
    buffer_load_dwordx4 v7, s[60:63], s73 offen offset:2048 lds
    s_mov_b64 exec, 3
    buffer_load_dwordx4 v7, s[60:63], s73 offen offset:3072 lds
    s_mov_b64 exec, -1
    s_load_dword s71, s[24:25], 0
    s_mov_b32 s48, s24
    s_mov_b32 s49, s25
    s_mov_b32 s50, 20971520
    s_mov_b32 s51, 0x00020000
    s_lshl_b32 s72, s80, 2
    v_add_u32 v34, s72, v5
    v_mul_u32_u24 v32, 450, v4
    v_lshl_add_u32 v32, v34, 1, v32
    v_mul_u32_u24 v33, 8192, v34
    v_lshl_add_u32 v33, v4, 4, v33
    s_lshl_b32 s72, s68, 8
    s_add_u32 s72, s72, 4194304
    s_barrier
    s_waitcnt vmcnt(0) lgkmcnt(0)
    s_mul_i32 s71, s71, 1664525
    s_add_u32 s71, s71, 1013904223
    s_mov_b32 s92, s71
    s_mov_b32 s93, s71
    v_mov_b32 v29, 159764
    v_mov_b32 v30, 1
    s_mov_b64 exec, 1
    ds_add_u32 v29, v30
    s_mov_b64 exec, -1
    v_mov_b32 v29, 159764
    s_mov_b32 s79, 1280000
swb65:
    ds_read_b32 v30, v29
    s_waitcnt lgkmcnt(0)
    v_cmp_gt_u32 vcc, 4, v30
    s_cbranch_vccz swb65_ok
    s_sleep 1
    s_sub_u32 s79, s79, 1
    s_cbranch_scc0 swb65
swb65_ok:
    ds_read_u16 v64, v32 offset:0
    ds_read_u16 v68, v32 offset:32768
    ds_read_u16 v65, v32 offset:8192
    ds_read_u16 v69, v32 offset:40960
    ds_read_u16 v66, v32 offset:16384
    ds_read_u16 v70, v32 offset:49152
    ds_read_u16 v67, v32 offset:24576
    ds_read_u16 v71, v32 offset:57344
    ds_read_u16 v72, v32 offset:32
    ds_read_u16 v76, v32 offset:32800
    ds_read_u16 v73, v32 offset:8224
    ds_read_u16 v77, v32 offset:40992
    ds_read_u16 v74, v32 offset:16416
    ds_read_u16 v78, v32 offset:49184
    ds_read_u16 v75, v32 offset:24608
    ds_read_u16 v79, v32 offset:57376
    s_waitcnt lgkmcnt(8)
    v_lshl_or_b32 v64, v68, 16, v64
    v_lshl_or_b32 v65, v69, 16, v65
    v_lshl_or_b32 v66, v70, 16, v66
    v_lshl_or_b32 v67, v71, 16, v67
    buffer_store_dwordx4 v[64:67], v33, s[48:51], s72 offen sc1
    s_add_u32 s72, s72, 131072
    ds_read_u16 v80, v32 offset:64
    ds_read_u16 v84, v32 offset:32832
    ds_read_u16 v81, v32 offset:8256
    ds_read_u16 v85, v32 offset:41024
    ds_read_u16 v82, v32 offset:16448
    ds_read_u16 v86, v32 offset:49216
    ds_read_u16 v83, v32 offset:24640
    ds_read_u16 v87, v32 offset:57408
    s_waitcnt lgkmcnt(8)
    v_lshl_or_b32 v72, v76, 16, v72
    v_lshl_or_b32 v73, v77, 16, v73
    v_lshl_or_b32 v74, v78, 16, v74
    v_lshl_or_b32 v75, v79, 16, v75
    buffer_store_dwordx4 v[72:75], v33, s[48:51], s72 offen sc1
    s_add_u32 s72, s72, 131072
    ds_read_u16 v88, v32 offset:96
    ds_read_u16 v92, v32 offset:32864
    ds_read_u16 v89, v32 offset:8288
    ds_read_u16 v93, v32 offset:41056
    ds_read_u16 v90, v32 offset:16480
    ds_read_u16 v94, v32 offset:49248
    ds_read_u16 v91, v32 offset:24672
    ds_read_u16 v95, v32 offset:57440
    s_waitcnt lgkmcnt(8)
    v_lshl_or_b32 v80, v84, 16, v80
    v_lshl_or_b32 v81, v85, 16, v81
    v_lshl_or_b32 v82, v86, 16, v82
    v_lshl_or_b32 v83, v87, 16, v83
    buffer_store_dwordx4 v[80:83], v33, s[48:51], s72 offen sc1
    s_add_u32 s72, s72, 131072
    ds_read_u16 v96, v32 offset:128
    ds_read_u16 v100, v32 offset:32896
    ds_read_u16 v97, v32 offset:8320
    ds_read_u16 v101, v32 offset:41088
    ds_read_u16 v98, v32 offset:16512
    ds_read_u16 v102, v32 offset:49280
    ds_read_u16 v99, v32 offset:24704
    ds_read_u16 v103, v32 offset:57472
    s_waitcnt lgkmcnt(8)
    v_lshl_or_b32 v88, v92, 16, v88
    v_lshl_or_b32 v89, v93, 16, v89
    v_lshl_or_b32 v90, v94, 16, v90
    v_lshl_or_b32 v91, v95, 16, v91
    buffer_store_dwordx4 v[88:91], v33, s[48:51], s72 offen sc1
    s_add_u32 s72, s72, 131072
    ds_read_u16 v104, v32 offset:160
    ds_read_u16 v108, v32 offset:32928
    ds_read_u16 v105, v32 offset:8352
    ds_read_u16 v109, v32 offset:41120
    ds_read_u16 v106, v32 offset:16544
    ds_read_u16 v110, v32 offset:49312
    ds_read_u16 v107, v32 offset:24736
    ds_read_u16 v111, v32 offset:57504
    s_waitcnt lgkmcnt(8)
    v_lshl_or_b32 v96, v100, 16, v96
    v_lshl_or_b32 v97, v101, 16, v97
    v_lshl_or_b32 v98, v102, 16, v98
    v_lshl_or_b32 v99, v103, 16, v99
    buffer_store_dwordx4 v[96:99], v33, s[48:51], s72 offen sc1
    s_add_u32 s72, s72, 131072
    ds_read_u16 v112, v32 offset:192
    ds_read_u16 v116, v32 offset:32960
    ds_read_u16 v113, v32 offset:8384
    ds_read_u16 v117, v32 offset:41152
    ds_read_u16 v114, v32 offset:16576
    ds_read_u16 v118, v32 offset:49344
    ds_read_u16 v115, v32 offset:24768
    ds_read_u16 v119, v32 offset:57536
    s_waitcnt lgkmcnt(8)
    v_lshl_or_b32 v104, v108, 16, v104
    v_lshl_or_b32 v105, v109, 16, v105
    v_lshl_or_b32 v106, v110, 16, v106
    v_lshl_or_b32 v107, v111, 16, v107
    buffer_store_dwordx4 v[104:107], v33, s[48:51], s72 offen sc1
    s_add_u32 s72, s72, 131072
    ds_read_u16 v120, v32 offset:224
    ds_read_u16 v124, v32 offset:32992
    ds_read_u16 v121, v32 offset:8416
    ds_read_u16 v125, v32 offset:41184
    ds_read_u16 v122, v32 offset:16608
    ds_read_u16 v126, v32 offset:49376
    ds_read_u16 v123, v32 offset:24800
    ds_read_u16 v127, v32 offset:57568
    s_waitcnt lgkmcnt(8)
    v_lshl_or_b32 v112, v116, 16, v112
    v_lshl_or_b32 v113, v117, 16, v113
    v_lshl_or_b32 v114, v118, 16, v114
    v_lshl_or_b32 v115, v119, 16, v115
    buffer_store_dwordx4 v[112:115], v33, s[48:51], s72 offen sc1
    s_add_u32 s72, s72, 131072
    ds_read_u16 v64, v32 offset:256
    ds_read_u16 v68, v32 offset:33024
    ds_read_u16 v65, v32 offset:8448
    ds_read_u16 v69, v32 offset:41216
    ds_read_u16 v66, v32 offset:16640
    ds_read_u16 v70, v32 offset:49408
    ds_read_u16 v67, v32 offset:24832
    ds_read_u16 v71, v32 offset:57600
    s_waitcnt lgkmcnt(8)
    v_lshl_or_b32 v120, v124, 16, v120
    v_lshl_or_b32 v121, v125, 16, v121
    v_lshl_or_b32 v122, v126, 16, v122
    v_lshl_or_b32 v123, v127, 16, v123
    buffer_store_dwordx4 v[120:123], v33, s[48:51], s72 offen sc1
    s_add_u32 s72, s72, 131072
    ds_read_u16 v72, v32 offset:288
    ds_read_u16 v76, v32 offset:33056
    ds_read_u16 v73, v32 offset:8480
    ds_read_u16 v77, v32 offset:41248
    ds_read_u16 v74, v32 offset:16672
    ds_read_u16 v78, v32 offset:49440
    ds_read_u16 v75, v32 offset:24864
    ds_read_u16 v79, v32 offset:57632
    s_waitcnt lgkmcnt(8)
    v_lshl_or_b32 v64, v68, 16, v64
    v_lshl_or_b32 v65, v69, 16, v65
    v_lshl_or_b32 v66, v70, 16, v66
    v_lshl_or_b32 v67, v71, 16, v67
    buffer_store_dwordx4 v[64:67], v33, s[48:51], s72 offen sc1
    s_add_u32 s72, s72, 131072
    ds_read_u16 v80, v32 offset:320
    ds_read_u16 v84, v32 offset:33088
    ds_read_u16 v81, v32 offset:8512
    ds_read_u16 v85, v32 offset:41280
    ds_read_u16 v82, v32 offset:16704
    ds_read_u16 v86, v32 offset:49472
    ds_read_u16 v83, v32 offset:24896
    ds_read_u16 v87, v32 offset:57664
    s_waitcnt lgkmcnt(8)
    v_lshl_or_b32 v72, v76, 16, v72
    v_lshl_or_b32 v73, v77, 16, v73
    v_lshl_or_b32 v74, v78, 16, v74
    v_lshl_or_b32 v75, v79, 16, v75
    buffer_store_dwordx4 v[72:75], v33, s[48:51], s72 offen sc1
    s_add_u32 s72, s72, 131072
    ds_read_u16 v88, v32 offset:352
    ds_read_u16 v92, v32 offset:33120
    ds_read_u16 v89, v32 offset:8544
    ds_read_u16 v93, v32 offset:41312
    ds_read_u16 v90, v32 offset:16736
    ds_read_u16 v94, v32 offset:49504
    ds_read_u16 v91, v32 offset:24928
    ds_read_u16 v95, v32 offset:57696
    s_waitcnt lgkmcnt(8)
    v_lshl_or_b32 v80, v84, 16, v80
    v_lshl_or_b32 v81, v85, 16, v81
    v_lshl_or_b32 v82, v86, 16, v82
    v_lshl_or_b32 v83, v87, 16, v83
    buffer_store_dwordx4 v[80:83], v33, s[48:51], s72 offen sc1
    s_add_u32 s72, s72, 131072
    ds_read_u16 v96, v32 offset:384
    ds_read_u16 v100, v32 offset:33152
    ds_read_u16 v97, v32 offset:8576
    ds_read_u16 v101, v32 offset:41344
    ds_read_u16 v98, v32 offset:16768
    ds_read_u16 v102, v32 offset:49536
    ds_read_u16 v99, v32 offset:24960
    ds_read_u16 v103, v32 offset:57728
    s_waitcnt lgkmcnt(8)
    v_lshl_or_b32 v88, v92, 16, v88
    v_lshl_or_b32 v89, v93, 16, v89
    v_lshl_or_b32 v90, v94, 16, v90
    v_lshl_or_b32 v91, v95, 16, v91
    buffer_store_dwordx4 v[88:91], v33, s[48:51], s72 offen sc1
    s_add_u32 s72, s72, 131072
    ds_read_u16 v104, v32 offset:416
    ds_read_u16 v108, v32 offset:33184
    ds_read_u16 v105, v32 offset:8608
    ds_read_u16 v109, v32 offset:41376
    ds_read_u16 v106, v32 offset:16800
    ds_read_u16 v110, v32 offset:49568
    ds_read_u16 v107, v32 offset:24992
    ds_read_u16 v111, v32 offset:57760
    s_waitcnt lgkmcnt(8)
    v_lshl_or_b32 v96, v100, 16, v96
    v_lshl_or_b32 v97, v101, 16, v97
    v_lshl_or_b32 v98, v102, 16, v98
    v_lshl_or_b32 v99, v103, 16, v99
    buffer_store_dwordx4 v[96:99], v33, s[48:51], s72 offen sc1
    s_add_u32 s72, s72, 131072
    ds_read_u16 v112, v32 offset:448
    ds_read_u16 v116, v32 offset:33216
    ds_read_u16 v113, v32 offset:8640
    ds_read_u16 v117, v32 offset:41408
    ds_read_u16 v114, v32 offset:16832
    ds_read_u16 v118, v32 offset:49600
    ds_read_u16 v115, v32 offset:25024
    ds_read_u16 v119, v32 offset:57792
    s_waitcnt lgkmcnt(8)
    v_lshl_or_b32 v104, v108, 16, v104
    v_lshl_or_b32 v105, v109, 16, v105
    v_lshl_or_b32 v106, v110, 16, v106
    v_lshl_or_b32 v107, v111, 16, v107
    buffer_store_dwordx4 v[104:107], v33, s[48:51], s72 offen sc1
    s_add_u32 s72, s72, 131072
    s_cmp_lg_u32 s80, 0
    s_cbranch_scc1 L_wtdone
    s_waitcnt lgkmcnt(0)
    v_lshl_or_b32 v112, v116, 16, v112
    v_lshl_or_b32 v113, v117, 16, v113
    v_lshl_or_b32 v114, v118, 16, v114
    v_lshl_or_b32 v115, v119, 16, v115
    buffer_store_dwordx4 v[112:115], v33, s[48:51], s72 offen sc1
    s_add_u32 s72, s72, 131072
L_wtdone:
    s_waitcnt lgkmcnt(0)
    s_waitcnt vmcnt(0)
    s_barrier
    s_cmp_eq_u32 s64, 0
    s_cbranch_scc0 L_sig2
    s_mul_i32 s72, s68, 16
    s_lshr_b32 s73, s72, 7
    s_mul_i32 s73, s73, 0
    s_add_u32 s72, s72, s73
    s_add_u32 s72, s72, 12288
    v_mov_b32 v26, s71
    s_mov_b64 exec, 1
    buffer_store_dword v26, v7, s[48:51], s72 offen sc1
    s_mov_b64 exec, -1
L_sig2:
    s_barrier
    s_cmp_eq_u32 s68, 0
    s_cbranch_scc0 L_fin
    v_lshlrev_b32 v34, 2, v5
    v_cvt_f32_u32 v34, v34
    v_cvt_f32_u32 v35, v4
    s_lshl_b32 s72, s64, 4
    v_cvt_f32_u32 v38, s72
    v_add_f32 v36, v38, v34
    v_add_f32 v32, 0x00000000, v35
    v_mul_f32 v32, 0x3a000000, v32
    v_mul_f32 v33, v32, v36
    v_mov_b32 v184, v33
    v_add_f32 v185, v32, v33
    v_fmamk_f32 v186, v32, 0x40000000, v33
    v_fmamk_f32 v187, v32, 0x40400000, v33
    v_add_f32 v32, 0x41800000, v35
    v_mul_f32 v32, 0x3a000000, v32
    v_mul_f32 v33, v32, v36
    v_mov_b32 v188, v33
    v_add_f32 v189, v32, v33
    v_fmamk_f32 v190, v32, 0x40000000, v33
    v_fmamk_f32 v191, v32, 0x40400000, v33
    v_cos_f32 v176, v184
    v_sin_f32 v184, v184
    v_cos_f32 v177, v185
    v_sin_f32 v185, v185
    v_cos_f32 v178, v186
    v_sin_f32 v186, v186
    v_cos_f32 v179, v187
    v_sin_f32 v187, v187
    v_cos_f32 v180, v188
    v_sin_f32 v188, v188
    v_cos_f32 v181, v189
    v_sin_f32 v189, v189
    v_cos_f32 v182, v190
    v_sin_f32 v190, v190
    v_cos_f32 v183, v191
    v_sin_f32 v191, v191
    v_add_f32 v32, v38, v35
    v_mul_f32 v32, 0x3c800000, v32
    v_mul_f32 v33, v32, v34
    v_mov_b32 v44, v33
    v_add_f32 v45, v32, v33
    v_fmamk_f32 v46, v32, 0x40000000, v33
    v_fmamk_f32 v47, v32, 0x40400000, v33
    v_cos_f32 v40, v44
    v_sin_f32 v44, v44
    v_cos_f32 v41, v45
    v_sin_f32 v45, v45
    v_cos_f32 v42, v46
    v_sin_f32 v46, v46
    v_cos_f32 v43, v47
    v_sin_f32 v47, v47
    v_cvt_pk_bf16_f32 v120, v40, v41
    v_cvt_pk_bf16_f32 v122, v44, v45
    v_cvt_pk_bf16_f32 v121, v42, v43
    v_cvt_pk_bf16_f32 v123, v46, v47
    v_mul_f32 v32, 0x3d000000, v32
    v_mul_f32 v33, 0x3d000000, v33
    v_mov_b32 v56, v33
    v_add_f32 v57, v32, v33
    v_fmamk_f32 v58, v32, 0x40000000, v33
    v_fmamk_f32 v59, v32, 0x40400000, v33
    v_fmamk_f32 v60, v32, 0x41800000, v33
    v_fmamk_f32 v61, v32, 0x41880000, v33
    v_fmamk_f32 v62, v32, 0x41900000, v33
    v_fmamk_f32 v63, v32, 0x41980000, v33
    v_cos_f32 v48, v56
    v_sin_f32 v56, v56
    v_cos_f32 v49, v57
    v_sin_f32 v57, v57
    v_cos_f32 v50, v58
    v_sin_f32 v58, v58
    v_cos_f32 v51, v59
    v_sin_f32 v59, v59
    v_cos_f32 v52, v60
    v_sin_f32 v60, v60
    v_cos_f32 v53, v61
    v_sin_f32 v61, v61
    v_cos_f32 v54, v62
    v_sin_f32 v62, v62
    v_cos_f32 v55, v63
    v_sin_f32 v63, v63
    v_mul_f32 v32, 0x3d000000, v35
    v_mul_f32 v33, v32, v34
    v_mov_b32 v44, v33
    v_add_f32 v45, v32, v33
    v_fmamk_f32 v46, v32, 0x40000000, v33
    v_fmamk_f32 v47, v32, 0x40400000, v33
    v_cos_f32 v40, v44
    v_sin_f32 v44, v44
    v_cos_f32 v41, v45
    v_sin_f32 v45, v45
    v_cos_f32 v42, v46
    v_sin_f32 v46, v46
    v_cos_f32 v43, v47
    v_sin_f32 v47, v47
    v_cvt_pk_bf16_f32 v124, v40, v41
    v_cvt_pk_bf16_f32 v126, v44, v45
    v_cvt_pk_bf16_f32 v125, v42, v43
    v_cvt_pk_bf16_f32 v127, v46, v47
    v_and_b32 v36, 1, v4
    v_mul_u32_u24 v36, 0x8000, v36
    v_lshl_or_b32 v36, v36, 16, v36
    v_and_b32 v37, 2, v4
    v_mul_u32_u24 v37, 0x4000, v37
    v_lshl_or_b32 v37, v37, 16, v37
    v_cmp_ne_u32 vcc, 0, v36
    v_mov_b64 v[130:131], v[120:121]
    v_xor_b32 v128, 0x80008000, v122
    v_mov_b64 v[132:133], v[122:123]
    v_xor_b32 v129, 0x80008000, v123
    v_mov_b64 v[154:155], v[124:125]
    v_xor_b32 v152, 0x80008000, v126
    v_mov_b64 v[156:157], v[126:127]
    v_xor_b32 v153, 0x80008000, v127
    v_cndmask_b32 v136, v130, v128, vcc
    v_cndmask_b32 v138, v132, v130, vcc
    v_cndmask_b32 v137, v131, v129, vcc
    v_cndmask_b32 v139, v133, v131, vcc
    v_xor_b32 v136, v37, v136
    v_xor_b32 v137, v37, v137
    v_xor_b32 v138, v37, v138
    v_xor_b32 v139, v37, v139
    v_xor_b32 v134, 0x80008000, v138
    v_xor_b32 v135, 0x80008000, v139
    v_xor_b32 v140, v36, v128
    v_xor_b32 v141, v36, v129
    v_xor_b32 v142, v36, v130
    v_xor_b32 v143, v36, v131
    v_xor_b32 v144, v36, v132
    v_xor_b32 v145, v36, v133
    v_xor_b32 v146, v36, v134
    v_xor_b32 v147, v36, v135
    v_xor_b32 v148, v36, v136
    v_xor_b32 v149, v36, v137
    v_xor_b32 v150, v36, v138
    v_xor_b32 v151, v36, v139
    v_xor_b32 v158, v36, v152
    v_xor_b32 v159, v36, v153
    v_xor_b32 v160, v36, v154
    v_xor_b32 v161, v36, v155
    v_xor_b32 v162, v36, v156
    v_xor_b32 v163, v36, v157
    v_xor_b32 v164, 0x80000000, v152
    v_xor_b32 v165, 0x80000000, v153
    v_xor_b32 v166, 0x80000000, v154
    v_xor_b32 v167, 0x80000000, v155
    v_xor_b32 v168, 0x80000000, v156
    v_xor_b32 v169, 0x80000000, v157
    v_xor_b32 v170, 0x80000000, v158
    v_xor_b32 v171, 0x80000000, v159
    v_xor_b32 v172, 0x80000000, v160
    v_xor_b32 v173, 0x80000000, v161
    v_xor_b32 v174, 0x80000000, v162
    v_xor_b32 v175, 0x80000000, v163
    s_mov_b32 s78, 224
    s_cmp_eq_u32 s78, 224
    s_cselect_b32 s20, 0, s78
    s_lshr_b32 s20, s20, 4
    s_lshl_b32 s20, s20, 2
    s_add_u32 s20, s20, s64
    s_mul_i32 s20, s20, 128
    s_add_u32 s20, s20, 4096
    v_lshlrev_b32 v8, 4, v2
    v_lshrrev_b32 v9, 7, v8
    v_mul_u32_u24 v9, 0, v9
    v_add_u32 v8, v8, v9
    v_add_u32 v8, 12288, v8
    v_mov_b32 v9, s71
    s_mov_b64 exec, -1
    buffer_load_dword v9, v8, s[48:51], 0 offen sc1
    s_mov_b64 exec, -1
    s_waitcnt vmcnt(0)
    v_cmp_ne_u32 vcc, s71, v9
    s_cbranch_vccz poll66_ok
    s_mov_b32 s79, 20000
poll66:
    buffer_load_dword v9, v8, s[48:51], 0 offen sc1
    s_mov_b64 exec, -1
    s_waitcnt vmcnt(0)
    v_cmp_ne_u32 vcc, s71, v9
    s_cbranch_vccz poll66_ok
    s_sleep 4
    s_sub_u32 s79, s79, 1
    s_cbranch_scc0 poll66
poll66_ok:
    s_lshl_b32 s73, s64, 11
    s_mul_i32 s72, s78, 8192
    s_add_u32 s22, s72, s73
    s_add_u32 s72, s22, 4194304
    s_add_u32 s74, s73, 65536
    buffer_load_dwordx4 v[104:107], v7, s[48:51], s72 offen offset:0 sc1
    buffer_load_dwordx4 v[108:111], v7, s[48:51], s72 offen offset:1024 sc1
    buffer_load_dwordx4 v[96:99], v7, s[48:51], s74 offen offset:0 sc1
    buffer_load_dwordx4 v[100:103], v7, s[48:51], s74 offen offset:1024 sc1
    s_load_dwordx16 s[4:19], s[24:25], s20 glc
    s_mov_b32 s85, 1
    s_waitcnt vmcnt(0)
    s_branch L_p2
L_gate:
    v_mov_b32 v32, 0
    v_lshlrev_b32 v33, 2, v1
    v_add_u32 v33, 159744, v33
    ds_write_b32 v33, v32
    s_lshl_b32 s72, s68, 6
    s_lshl_b32 s73, s80, 4
    s_add_u32 s74, s72, s73
    v_lshrrev_b32 v37, 3, v1
    v_add_u32 v37, s74, v37
    v_bfe_u32 v36, v37, 2, 4
    v_bfe_u32 v38, v37, 8, 1
    v_lshl_add_u32 v36, v38, 4, v36
    v_and_b32 v38, 3, v37
    v_lshl_add_u32 v36, v38, 5, v36
    v_and_b32 v38, 0xc0, v37
    v_lshl_add_u32 v36, v38, 1, v36
    v_and_b32 v38, 0x600, v37
    v_add_u32 v36, v36, v38
    v_mul_u32_u24 v36, 896, v36
    v_and_b32 v6, 7, v1
    v_lshlrev_b32 v6, 4, v6
    v_add_u32 v36, v36, v6
    s_waitcnt lgkmcnt(0)
    s_barrier
    s_mov_b32 s28, s4
    s_mov_b32 s29, s5
    s_mov_b32 s30, 1835008
    s_mov_b32 s31, 0x00020000
    s_mov_b32 s36, s18
    s_mov_b32 s37, s19
    s_mov_b32 s38, 896
    s_mov_b32 s39, 0x00020000
    s_mov_b32 s48, s24
    s_mov_b32 s49, s25
    s_mov_b32 s50, 20971520
    s_mov_b32 s51, 0x00020000
    s_mov_b32 s40, s16
    s_mov_b32 s41, s17
    s_mov_b32 s42, 1605632
    s_mov_b32 s43, 0x00020000
    buffer_load_dwordx4 v[128:131], v6, s[36:39], 0 offen offset:0
    buffer_load_dwordx4 v[64:67], v36, s[28:31], 0 offen offset:0
    buffer_load_dwordx4 v[92:95], v36, s[28:31], 0 offen offset:1792
    buffer_load_dwordx4 v[132:135], v6, s[36:39], 0 offen offset:128
    buffer_load_dwordx4 v[68:71], v36, s[28:31], 0 offen offset:128
    buffer_load_dwordx4 v[96:99], v36, s[28:31], 0 offen offset:1920
    buffer_load_dwordx4 v[136:139], v6, s[36:39], 0 offen offset:256
    buffer_load_dwordx4 v[72:75], v36, s[28:31], 0 offen offset:256
    buffer_load_dwordx4 v[100:103], v36, s[28:31], 0 offen offset:2048
    buffer_load_dwordx4 v[140:143], v6, s[36:39], 0 offen offset:384
    buffer_load_dwordx4 v[76:79], v36, s[28:31], 0 offen offset:384
    buffer_load_dwordx4 v[104:107], v36, s[28:31], 0 offen offset:2176
    buffer_load_dwordx4 v[144:147], v6, s[36:39], 0 offen offset:512
    buffer_load_dwordx4 v[80:83], v36, s[28:31], 0 offen offset:512
    buffer_load_dwordx4 v[108:111], v36, s[28:31], 0 offen offset:2304
    buffer_load_dwordx4 v[148:151], v6, s[36:39], 0 offen offset:640
    buffer_load_dwordx4 v[84:87], v36, s[28:31], 0 offen offset:640
    buffer_load_dwordx4 v[112:115], v36, s[28:31], 0 offen offset:2432
    buffer_load_dwordx4 v[152:155], v6, s[36:39], 0 offen offset:768
    buffer_load_dwordx4 v[88:91], v36, s[28:31], 0 offen offset:768
    buffer_load_dwordx4 v[116:119], v36, s[28:31], 0 offen offset:2560
    s_mov_b32 s73, 0xffff0000
    v_mov_b32 v48, 0
    v_mov_b32 v49, 0
    v_mov_b32 v50, 0
    v_mov_b32 v51, 0
    s_waitcnt vmcnt(18)
    v_lshlrev_b32 v44, 16, v128
    v_and_b32 v45, s73, v128
    v_lshlrev_b32 v40, 16, v64
    v_and_b32 v41, s73, v64
    v_pk_mul_f32 v[40:41], v[40:41], v[44:45]
    v_cvt_pk_bf16_f32 v46, v40, v41
    v_lshlrev_b32 v40, 16, v46
    v_and_b32 v41, s73, v46
    v_pk_add_f32 v[48:49], v[48:49], v[40:41]
    v_lshlrev_b32 v42, 16, v92
    v_and_b32 v43, s73, v92
    v_pk_mul_f32 v[42:43], v[42:43], v[44:45]
    v_cvt_pk_bf16_f32 v47, v42, v43
    v_lshlrev_b32 v42, 16, v47
    v_and_b32 v43, s73, v47
    v_pk_add_f32 v[50:51], v[50:51], v[42:43]
    v_lshlrev_b32 v44, 16, v129
    v_and_b32 v45, s73, v129
    v_lshlrev_b32 v40, 16, v65
    v_and_b32 v41, s73, v65
    v_pk_mul_f32 v[40:41], v[40:41], v[44:45]
    v_cvt_pk_bf16_f32 v46, v40, v41
    v_lshlrev_b32 v40, 16, v46
    v_and_b32 v41, s73, v46
    v_pk_add_f32 v[48:49], v[48:49], v[40:41]
    v_lshlrev_b32 v42, 16, v93
    v_and_b32 v43, s73, v93
    v_pk_mul_f32 v[42:43], v[42:43], v[44:45]
    v_cvt_pk_bf16_f32 v47, v42, v43
    v_lshlrev_b32 v42, 16, v47
    v_and_b32 v43, s73, v47
    v_pk_add_f32 v[50:51], v[50:51], v[42:43]
    v_lshlrev_b32 v44, 16, v130
    v_and_b32 v45, s73, v130
    v_lshlrev_b32 v40, 16, v66
    v_and_b32 v41, s73, v66
    v_pk_mul_f32 v[40:41], v[40:41], v[44:45]
    v_cvt_pk_bf16_f32 v46, v40, v41
    v_lshlrev_b32 v40, 16, v46
    v_and_b32 v41, s73, v46
    v_pk_add_f32 v[48:49], v[48:49], v[40:41]
    v_lshlrev_b32 v42, 16, v94
    v_and_b32 v43, s73, v94
    v_pk_mul_f32 v[42:43], v[42:43], v[44:45]
    v_cvt_pk_bf16_f32 v47, v42, v43
    v_lshlrev_b32 v42, 16, v47
    v_and_b32 v43, s73, v47
    v_pk_add_f32 v[50:51], v[50:51], v[42:43]
    v_lshlrev_b32 v44, 16, v131
    v_and_b32 v45, s73, v131
    v_lshlrev_b32 v40, 16, v67
    v_and_b32 v41, s73, v67
    v_pk_mul_f32 v[40:41], v[40:41], v[44:45]
    v_cvt_pk_bf16_f32 v46, v40, v41
    v_lshlrev_b32 v40, 16, v46
    v_and_b32 v41, s73, v46
    v_pk_add_f32 v[48:49], v[48:49], v[40:41]
    v_lshlrev_b32 v42, 16, v95
    v_and_b32 v43, s73, v95
    v_pk_mul_f32 v[42:43], v[42:43], v[44:45]
    v_cvt_pk_bf16_f32 v47, v42, v43
    v_lshlrev_b32 v42, 16, v47
    v_and_b32 v43, s73, v47
    v_pk_add_f32 v[50:51], v[50:51], v[42:43]
    s_waitcnt vmcnt(15)
    v_lshlrev_b32 v44, 16, v132
    v_and_b32 v45, s73, v132
    v_lshlrev_b32 v40, 16, v68
    v_and_b32 v41, s73, v68
    v_pk_mul_f32 v[40:41], v[40:41], v[44:45]
    v_cvt_pk_bf16_f32 v46, v40, v41
    v_lshlrev_b32 v40, 16, v46
    v_and_b32 v41, s73, v46
    v_pk_add_f32 v[48:49], v[48:49], v[40:41]
    v_lshlrev_b32 v42, 16, v96
    v_and_b32 v43, s73, v96
    v_pk_mul_f32 v[42:43], v[42:43], v[44:45]
    v_cvt_pk_bf16_f32 v47, v42, v43
    v_lshlrev_b32 v42, 16, v47
    v_and_b32 v43, s73, v47
    v_pk_add_f32 v[50:51], v[50:51], v[42:43]
    v_lshlrev_b32 v44, 16, v133
    v_and_b32 v45, s73, v133
    v_lshlrev_b32 v40, 16, v69
    v_and_b32 v41, s73, v69
    v_pk_mul_f32 v[40:41], v[40:41], v[44:45]
    v_cvt_pk_bf16_f32 v46, v40, v41
    v_lshlrev_b32 v40, 16, v46
    v_and_b32 v41, s73, v46
    v_pk_add_f32 v[48:49], v[48:49], v[40:41]
    v_lshlrev_b32 v42, 16, v97
    v_and_b32 v43, s73, v97
    v_pk_mul_f32 v[42:43], v[42:43], v[44:45]
    v_cvt_pk_bf16_f32 v47, v42, v43
    v_lshlrev_b32 v42, 16, v47
    v_and_b32 v43, s73, v47
    v_pk_add_f32 v[50:51], v[50:51], v[42:43]
    v_lshlrev_b32 v44, 16, v134
    v_and_b32 v45, s73, v134
    v_lshlrev_b32 v40, 16, v70
    v_and_b32 v41, s73, v70
    v_pk_mul_f32 v[40:41], v[40:41], v[44:45]
    v_cvt_pk_bf16_f32 v46, v40, v41
    v_lshlrev_b32 v40, 16, v46
    v_and_b32 v41, s73, v46
    v_pk_add_f32 v[48:49], v[48:49], v[40:41]
    v_lshlrev_b32 v42, 16, v98
    v_and_b32 v43, s73, v98
    v_pk_mul_f32 v[42:43], v[42:43], v[44:45]
    v_cvt_pk_bf16_f32 v47, v42, v43
    v_lshlrev_b32 v42, 16, v47
    v_and_b32 v43, s73, v47
    v_pk_add_f32 v[50:51], v[50:51], v[42:43]
    v_lshlrev_b32 v44, 16, v135
    v_and_b32 v45, s73, v135
    v_lshlrev_b32 v40, 16, v71
    v_and_b32 v41, s73, v71
    v_pk_mul_f32 v[40:41], v[40:41], v[44:45]
    v_cvt_pk_bf16_f32 v46, v40, v41
    v_lshlrev_b32 v40, 16, v46
    v_and_b32 v41, s73, v46
    v_pk_add_f32 v[48:49], v[48:49], v[40:41]
    v_lshlrev_b32 v42, 16, v99
    v_and_b32 v43, s73, v99
    v_pk_mul_f32 v[42:43], v[42:43], v[44:45]
    v_cvt_pk_bf16_f32 v47, v42, v43
    v_lshlrev_b32 v42, 16, v47
    v_and_b32 v43, s73, v47
    v_pk_add_f32 v[50:51], v[50:51], v[42:43]
    s_waitcnt vmcnt(12)
    v_lshlrev_b32 v44, 16, v136
    v_and_b32 v45, s73, v136
    v_lshlrev_b32 v40, 16, v72
    v_and_b32 v41, s73, v72
    v_pk_mul_f32 v[40:41], v[40:41], v[44:45]
    v_cvt_pk_bf16_f32 v46, v40, v41
    v_lshlrev_b32 v40, 16, v46
    v_and_b32 v41, s73, v46
    v_pk_add_f32 v[48:49], v[48:49], v[40:41]
    v_lshlrev_b32 v42, 16, v100
    v_and_b32 v43, s73, v100
    v_pk_mul_f32 v[42:43], v[42:43], v[44:45]
    v_cvt_pk_bf16_f32 v47, v42, v43
    v_lshlrev_b32 v42, 16, v47
    v_and_b32 v43, s73, v47
    v_pk_add_f32 v[50:51], v[50:51], v[42:43]
    v_lshlrev_b32 v44, 16, v137
    v_and_b32 v45, s73, v137
    v_lshlrev_b32 v40, 16, v73
    v_and_b32 v41, s73, v73
    v_pk_mul_f32 v[40:41], v[40:41], v[44:45]
    v_cvt_pk_bf16_f32 v46, v40, v41
    v_lshlrev_b32 v40, 16, v46
    v_and_b32 v41, s73, v46
    v_pk_add_f32 v[48:49], v[48:49], v[40:41]
    v_lshlrev_b32 v42, 16, v101
    v_and_b32 v43, s73, v101
    v_pk_mul_f32 v[42:43], v[42:43], v[44:45]
    v_cvt_pk_bf16_f32 v47, v42, v43
    v_lshlrev_b32 v42, 16, v47
    v_and_b32 v43, s73, v47
    v_pk_add_f32 v[50:51], v[50:51], v[42:43]
    v_lshlrev_b32 v44, 16, v138
    v_and_b32 v45, s73, v138
    v_lshlrev_b32 v40, 16, v74
    v_and_b32 v41, s73, v74
    v_pk_mul_f32 v[40:41], v[40:41], v[44:45]
    v_cvt_pk_bf16_f32 v46, v40, v41
    v_lshlrev_b32 v40, 16, v46
    v_and_b32 v41, s73, v46
    v_pk_add_f32 v[48:49], v[48:49], v[40:41]
    v_lshlrev_b32 v42, 16, v102
    v_and_b32 v43, s73, v102
    v_pk_mul_f32 v[42:43], v[42:43], v[44:45]
    v_cvt_pk_bf16_f32 v47, v42, v43
    v_lshlrev_b32 v42, 16, v47
    v_and_b32 v43, s73, v47
    v_pk_add_f32 v[50:51], v[50:51], v[42:43]
    v_lshlrev_b32 v44, 16, v139
    v_and_b32 v45, s73, v139
    v_lshlrev_b32 v40, 16, v75
    v_and_b32 v41, s73, v75
    v_pk_mul_f32 v[40:41], v[40:41], v[44:45]
    v_cvt_pk_bf16_f32 v46, v40, v41
    v_lshlrev_b32 v40, 16, v46
    v_and_b32 v41, s73, v46
    v_pk_add_f32 v[48:49], v[48:49], v[40:41]
    v_lshlrev_b32 v42, 16, v103
    v_and_b32 v43, s73, v103
    v_pk_mul_f32 v[42:43], v[42:43], v[44:45]
    v_cvt_pk_bf16_f32 v47, v42, v43
    v_lshlrev_b32 v42, 16, v47
    v_and_b32 v43, s73, v47
    v_pk_add_f32 v[50:51], v[50:51], v[42:43]
    s_waitcnt vmcnt(9)
    v_lshlrev_b32 v44, 16, v140
    v_and_b32 v45, s73, v140
    v_lshlrev_b32 v40, 16, v76
    v_and_b32 v41, s73, v76
    v_pk_mul_f32 v[40:41], v[40:41], v[44:45]
    v_cvt_pk_bf16_f32 v46, v40, v41
    v_lshlrev_b32 v40, 16, v46
    v_and_b32 v41, s73, v46
    v_pk_add_f32 v[48:49], v[48:49], v[40:41]
    v_lshlrev_b32 v42, 16, v104
    v_and_b32 v43, s73, v104
    v_pk_mul_f32 v[42:43], v[42:43], v[44:45]
    v_cvt_pk_bf16_f32 v47, v42, v43
    v_lshlrev_b32 v42, 16, v47
    v_and_b32 v43, s73, v47
    v_pk_add_f32 v[50:51], v[50:51], v[42:43]
    v_lshlrev_b32 v44, 16, v141
    v_and_b32 v45, s73, v141
    v_lshlrev_b32 v40, 16, v77
    v_and_b32 v41, s73, v77
    v_pk_mul_f32 v[40:41], v[40:41], v[44:45]
    v_cvt_pk_bf16_f32 v46, v40, v41
    v_lshlrev_b32 v40, 16, v46
    v_and_b32 v41, s73, v46
    v_pk_add_f32 v[48:49], v[48:49], v[40:41]
    v_lshlrev_b32 v42, 16, v105
    v_and_b32 v43, s73, v105
    v_pk_mul_f32 v[42:43], v[42:43], v[44:45]
    v_cvt_pk_bf16_f32 v47, v42, v43
    v_lshlrev_b32 v42, 16, v47
    v_and_b32 v43, s73, v47
    v_pk_add_f32 v[50:51], v[50:51], v[42:43]
    v_lshlrev_b32 v44, 16, v142
    v_and_b32 v45, s73, v142
    v_lshlrev_b32 v40, 16, v78
    v_and_b32 v41, s73, v78
    v_pk_mul_f32 v[40:41], v[40:41], v[44:45]
    v_cvt_pk_bf16_f32 v46, v40, v41
    v_lshlrev_b32 v40, 16, v46
    v_and_b32 v41, s73, v46
    v_pk_add_f32 v[48:49], v[48:49], v[40:41]
    v_lshlrev_b32 v42, 16, v106
    v_and_b32 v43, s73, v106
    v_pk_mul_f32 v[42:43], v[42:43], v[44:45]
    v_cvt_pk_bf16_f32 v47, v42, v43
    v_lshlrev_b32 v42, 16, v47
    v_and_b32 v43, s73, v47
    v_pk_add_f32 v[50:51], v[50:51], v[42:43]
    v_lshlrev_b32 v44, 16, v143
    v_and_b32 v45, s73, v143
    v_lshlrev_b32 v40, 16, v79
    v_and_b32 v41, s73, v79
    v_pk_mul_f32 v[40:41], v[40:41], v[44:45]
    v_cvt_pk_bf16_f32 v46, v40, v41
    v_lshlrev_b32 v40, 16, v46
    v_and_b32 v41, s73, v46
    v_pk_add_f32 v[48:49], v[48:49], v[40:41]
    v_lshlrev_b32 v42, 16, v107
    v_and_b32 v43, s73, v107
    v_pk_mul_f32 v[42:43], v[42:43], v[44:45]
    v_cvt_pk_bf16_f32 v47, v42, v43
    v_lshlrev_b32 v42, 16, v47
    v_and_b32 v43, s73, v47
    v_pk_add_f32 v[50:51], v[50:51], v[42:43]
    s_waitcnt vmcnt(6)
    v_lshlrev_b32 v44, 16, v144
    v_and_b32 v45, s73, v144
    v_lshlrev_b32 v40, 16, v80
    v_and_b32 v41, s73, v80
    v_pk_mul_f32 v[40:41], v[40:41], v[44:45]
    v_cvt_pk_bf16_f32 v46, v40, v41
    v_lshlrev_b32 v40, 16, v46
    v_and_b32 v41, s73, v46
    v_pk_add_f32 v[48:49], v[48:49], v[40:41]
    v_lshlrev_b32 v42, 16, v108
    v_and_b32 v43, s73, v108
    v_pk_mul_f32 v[42:43], v[42:43], v[44:45]
    v_cvt_pk_bf16_f32 v47, v42, v43
    v_lshlrev_b32 v42, 16, v47
    v_and_b32 v43, s73, v47
    v_pk_add_f32 v[50:51], v[50:51], v[42:43]
    v_lshlrev_b32 v44, 16, v145
    v_and_b32 v45, s73, v145
    v_lshlrev_b32 v40, 16, v81
    v_and_b32 v41, s73, v81
    v_pk_mul_f32 v[40:41], v[40:41], v[44:45]
    v_cvt_pk_bf16_f32 v46, v40, v41
    v_lshlrev_b32 v40, 16, v46
    v_and_b32 v41, s73, v46
    v_pk_add_f32 v[48:49], v[48:49], v[40:41]
    v_lshlrev_b32 v42, 16, v109
    v_and_b32 v43, s73, v109
    v_pk_mul_f32 v[42:43], v[42:43], v[44:45]
    v_cvt_pk_bf16_f32 v47, v42, v43
    v_lshlrev_b32 v42, 16, v47
    v_and_b32 v43, s73, v47
    v_pk_add_f32 v[50:51], v[50:51], v[42:43]
    v_lshlrev_b32 v44, 16, v146
    v_and_b32 v45, s73, v146
    v_lshlrev_b32 v40, 16, v82
    v_and_b32 v41, s73, v82
    v_pk_mul_f32 v[40:41], v[40:41], v[44:45]
    v_cvt_pk_bf16_f32 v46, v40, v41
    v_lshlrev_b32 v40, 16, v46
    v_and_b32 v41, s73, v46
    v_pk_add_f32 v[48:49], v[48:49], v[40:41]
    v_lshlrev_b32 v42, 16, v110
    v_and_b32 v43, s73, v110
    v_pk_mul_f32 v[42:43], v[42:43], v[44:45]
    v_cvt_pk_bf16_f32 v47, v42, v43
    v_lshlrev_b32 v42, 16, v47
    v_and_b32 v43, s73, v47
    v_pk_add_f32 v[50:51], v[50:51], v[42:43]
    v_lshlrev_b32 v44, 16, v147
    v_and_b32 v45, s73, v147
    v_lshlrev_b32 v40, 16, v83
    v_and_b32 v41, s73, v83
    v_pk_mul_f32 v[40:41], v[40:41], v[44:45]
    v_cvt_pk_bf16_f32 v46, v40, v41
    v_lshlrev_b32 v40, 16, v46
    v_and_b32 v41, s73, v46
    v_pk_add_f32 v[48:49], v[48:49], v[40:41]
    v_lshlrev_b32 v42, 16, v111
    v_and_b32 v43, s73, v111
    v_pk_mul_f32 v[42:43], v[42:43], v[44:45]
    v_cvt_pk_bf16_f32 v47, v42, v43
    v_lshlrev_b32 v42, 16, v47
    v_and_b32 v43, s73, v47
    v_pk_add_f32 v[50:51], v[50:51], v[42:43]
    s_waitcnt vmcnt(3)
    v_lshlrev_b32 v44, 16, v148
    v_and_b32 v45, s73, v148
    v_lshlrev_b32 v40, 16, v84
    v_and_b32 v41, s73, v84
    v_pk_mul_f32 v[40:41], v[40:41], v[44:45]
    v_cvt_pk_bf16_f32 v46, v40, v41
    v_lshlrev_b32 v40, 16, v46
    v_and_b32 v41, s73, v46
    v_pk_add_f32 v[48:49], v[48:49], v[40:41]
    v_lshlrev_b32 v42, 16, v112
    v_and_b32 v43, s73, v112
    v_pk_mul_f32 v[42:43], v[42:43], v[44:45]
    v_cvt_pk_bf16_f32 v47, v42, v43
    v_lshlrev_b32 v42, 16, v47
    v_and_b32 v43, s73, v47
    v_pk_add_f32 v[50:51], v[50:51], v[42:43]
    v_lshlrev_b32 v44, 16, v149
    v_and_b32 v45, s73, v149
    v_lshlrev_b32 v40, 16, v85
    v_and_b32 v41, s73, v85
    v_pk_mul_f32 v[40:41], v[40:41], v[44:45]
    v_cvt_pk_bf16_f32 v46, v40, v41
    v_lshlrev_b32 v40, 16, v46
    v_and_b32 v41, s73, v46
    v_pk_add_f32 v[48:49], v[48:49], v[40:41]
    v_lshlrev_b32 v42, 16, v113
    v_and_b32 v43, s73, v113
    v_pk_mul_f32 v[42:43], v[42:43], v[44:45]
    v_cvt_pk_bf16_f32 v47, v42, v43
    v_lshlrev_b32 v42, 16, v47
    v_and_b32 v43, s73, v47
    v_pk_add_f32 v[50:51], v[50:51], v[42:43]
    v_lshlrev_b32 v44, 16, v150
    v_and_b32 v45, s73, v150
    v_lshlrev_b32 v40, 16, v86
    v_and_b32 v41, s73, v86
    v_pk_mul_f32 v[40:41], v[40:41], v[44:45]
    v_cvt_pk_bf16_f32 v46, v40, v41
    v_lshlrev_b32 v40, 16, v46
    v_and_b32 v41, s73, v46
    v_pk_add_f32 v[48:49], v[48:49], v[40:41]
    v_lshlrev_b32 v42, 16, v114
    v_and_b32 v43, s73, v114
    v_pk_mul_f32 v[42:43], v[42:43], v[44:45]
    v_cvt_pk_bf16_f32 v47, v42, v43
    v_lshlrev_b32 v42, 16, v47
    v_and_b32 v43, s73, v47
    v_pk_add_f32 v[50:51], v[50:51], v[42:43]
    v_lshlrev_b32 v44, 16, v151
    v_and_b32 v45, s73, v151
    v_lshlrev_b32 v40, 16, v87
    v_and_b32 v41, s73, v87
    v_pk_mul_f32 v[40:41], v[40:41], v[44:45]
    v_cvt_pk_bf16_f32 v46, v40, v41
    v_lshlrev_b32 v40, 16, v46
    v_and_b32 v41, s73, v46
    v_pk_add_f32 v[48:49], v[48:49], v[40:41]
    v_lshlrev_b32 v42, 16, v115
    v_and_b32 v43, s73, v115
    v_pk_mul_f32 v[42:43], v[42:43], v[44:45]
    v_cvt_pk_bf16_f32 v47, v42, v43
    v_lshlrev_b32 v42, 16, v47
    v_and_b32 v43, s73, v47
    v_pk_add_f32 v[50:51], v[50:51], v[42:43]
    s_waitcnt vmcnt(0)
    v_lshlrev_b32 v44, 16, v152
    v_and_b32 v45, s73, v152
    v_lshlrev_b32 v40, 16, v88
    v_and_b32 v41, s73, v88
    v_pk_mul_f32 v[40:41], v[40:41], v[44:45]
    v_cvt_pk_bf16_f32 v46, v40, v41
    v_lshlrev_b32 v40, 16, v46
    v_and_b32 v41, s73, v46
    v_pk_add_f32 v[48:49], v[48:49], v[40:41]
    v_lshlrev_b32 v42, 16, v116
    v_and_b32 v43, s73, v116
    v_pk_mul_f32 v[42:43], v[42:43], v[44:45]
    v_cvt_pk_bf16_f32 v47, v42, v43
    v_lshlrev_b32 v42, 16, v47
    v_and_b32 v43, s73, v47
    v_pk_add_f32 v[50:51], v[50:51], v[42:43]
    v_lshlrev_b32 v44, 16, v153
    v_and_b32 v45, s73, v153
    v_lshlrev_b32 v40, 16, v89
    v_and_b32 v41, s73, v89
    v_pk_mul_f32 v[40:41], v[40:41], v[44:45]
    v_cvt_pk_bf16_f32 v46, v40, v41
    v_lshlrev_b32 v40, 16, v46
    v_and_b32 v41, s73, v46
    v_pk_add_f32 v[48:49], v[48:49], v[40:41]
    v_lshlrev_b32 v42, 16, v117
    v_and_b32 v43, s73, v117
    v_pk_mul_f32 v[42:43], v[42:43], v[44:45]
    v_cvt_pk_bf16_f32 v47, v42, v43
    v_lshlrev_b32 v42, 16, v47
    v_and_b32 v43, s73, v47
    v_pk_add_f32 v[50:51], v[50:51], v[42:43]
    v_lshlrev_b32 v44, 16, v154
    v_and_b32 v45, s73, v154
    v_lshlrev_b32 v40, 16, v90
    v_and_b32 v41, s73, v90
    v_pk_mul_f32 v[40:41], v[40:41], v[44:45]
    v_cvt_pk_bf16_f32 v46, v40, v41
    v_lshlrev_b32 v40, 16, v46
    v_and_b32 v41, s73, v46
    v_pk_add_f32 v[48:49], v[48:49], v[40:41]
    v_lshlrev_b32 v42, 16, v118
    v_and_b32 v43, s73, v118
    v_pk_mul_f32 v[42:43], v[42:43], v[44:45]
    v_cvt_pk_bf16_f32 v47, v42, v43
    v_lshlrev_b32 v42, 16, v47
    v_and_b32 v43, s73, v47
    v_pk_add_f32 v[50:51], v[50:51], v[42:43]
    v_lshlrev_b32 v44, 16, v155
    v_and_b32 v45, s73, v155
    v_lshlrev_b32 v40, 16, v91
    v_and_b32 v41, s73, v91
    v_pk_mul_f32 v[40:41], v[40:41], v[44:45]
    v_cvt_pk_bf16_f32 v46, v40, v41
    v_lshlrev_b32 v40, 16, v46
    v_and_b32 v41, s73, v46
    v_pk_add_f32 v[48:49], v[48:49], v[40:41]
    v_lshlrev_b32 v42, 16, v119
    v_and_b32 v43, s73, v119
    v_pk_mul_f32 v[42:43], v[42:43], v[44:45]
    v_cvt_pk_bf16_f32 v47, v42, v43
    v_lshlrev_b32 v42, 16, v47
    v_and_b32 v43, s73, v47
    v_pk_add_f32 v[50:51], v[50:51], v[42:43]
    v_lshlrev_b32 v6, 2, v37
    s_mov_b32 s72, 65536
    v_add_f32 v48, v48, v49
    s_nop 1
    v_add_f32_dpp v48, v48, v48 quad_perm:[1,0,3,2] row_mask:0xf bank_mask:0xf
    s_nop 1
    v_add_f32_dpp v48, v48, v48 quad_perm:[2,3,0,1] row_mask:0xf bank_mask:0xf
    s_nop 1
    v_add_f32_dpp v48, v48, v48 row_half_mirror row_mask:0xf bank_mask:0xf
    v_cvt_pk_bf16_f32 v48, v48, v48
    v_lshlrev_b32 v48, 16, v48
    v_mul_f32 v48, 0xbfb8aa3b, v48
    v_exp_f32 v48, v48
    s_nop 0
    v_add_f32 v48, 1.0, v48
    v_rcp_f32 v48, v48
    s_nop 0
    v_cvt_pk_bf16_f32 v48, v48, v48
    v_lshlrev_b32 v48, 16, v48
    buffer_store_dword v48, v6, s[48:51], s72 offen offset:0 sc1
    v_add_f32 v50, v50, v51
    s_nop 1
    v_add_f32_dpp v50, v50, v50 quad_perm:[1,0,3,2] row_mask:0xf bank_mask:0xf
    s_nop 1
    v_add_f32_dpp v50, v50, v50 quad_perm:[2,3,0,1] row_mask:0xf bank_mask:0xf
    s_nop 1
    v_add_f32_dpp v50, v50, v50 row_half_mirror row_mask:0xf bank_mask:0xf
    v_cvt_pk_bf16_f32 v50, v50, v50
    v_lshlrev_b32 v50, 16, v50
    v_mul_f32 v50, 0xbfb8aa3b, v50
    v_exp_f32 v50, v50
    s_nop 0
    v_add_f32 v50, 1.0, v50
    v_rcp_f32 v50, v50
    s_nop 0
    v_cvt_pk_bf16_f32 v50, v50, v50
    v_lshlrev_b32 v50, 16, v50
    buffer_store_dword v50, v6, s[48:51], s72 offen offset:32 sc1
    s_waitcnt vmcnt(0)
    s_barrier
    s_barrier
    s_cmp_eq_u32 s68, 0
    s_cbranch_scc1 L_fin
    v_min_u32 v8, 48, v1
    v_lshlrev_b32 v8, 7, v8
    s_lshl_b32 s22, s66, 2
    s_add_u32 s22, s22, s80
    s_mul_i32 s22, s22, 6272
    s_and_b32 s72, s67, 1
    s_mul_i32 s72, s72, 802816
    s_add_u32 s22, s22, s72
    s_and_b32 s72, s67, 6
    s_add_u32 s73, s72, 0
    s_and_b32 s73, s73, 7
    s_mul_i32 s73, s73, 100352
    s_add_u32 s73, s73, s22
    buffer_load_dword v23, v8, s[40:43], s73 offen
    s_add_u32 s73, s72, 1
    s_and_b32 s73, s73, 7
    s_mul_i32 s73, s73, 100352
    s_add_u32 s73, s73, s22
    buffer_load_dword v23, v8, s[40:43], s73 offen
    s_add_u32 s73, s72, 2
    s_and_b32 s73, s73, 7
    s_mul_i32 s73, s73, 100352
    s_add_u32 s73, s73, s22
    buffer_load_dword v23, v8, s[40:43], s73 offen
    s_add_u32 s73, s72, 3
    s_and_b32 s73, s73, 7
    s_mul_i32 s73, s73, 100352
    s_add_u32 s73, s73, s22
    buffer_load_dword v23, v8, s[40:43], s73 offen
    s_add_u32 s73, s72, 4
    s_and_b32 s73, s73, 7
    s_mul_i32 s73, s73, 100352
    s_add_u32 s73, s73, s22
    buffer_load_dword v23, v8, s[40:43], s73 offen
    s_add_u32 s73, s72, 5
    s_and_b32 s73, s73, 7
    s_mul_i32 s73, s73, 100352
    s_add_u32 s73, s73, s22
    buffer_load_dword v23, v8, s[40:43], s73 offen
    s_add_u32 s73, s72, 6
    s_and_b32 s73, s73, 7
    s_mul_i32 s73, s73, 100352
    s_add_u32 s73, s73, s22
    buffer_load_dword v23, v8, s[40:43], s73 offen
    s_add_u32 s73, s72, 7
    s_and_b32 s73, s73, 7
    s_mul_i32 s73, s73, 100352
    s_add_u32 s73, s73, s22
    buffer_load_dword v23, v8, s[40:43], s73 offen
L_fin:
L_end:
    s_endpgm
.section .rodata,"a"
.p2align 6
.amdhsa_kernel gated_mix__spectral_gfnet__dense_activation_mish__prompt_kernel
  .amdhsa_next_free_vgpr 256
  .amdhsa_next_free_sgpr 102
  .amdhsa_accum_offset 192
  .amdhsa_group_segment_fixed_size 0
  .amdhsa_kernarg_size 88
  .amdhsa_user_sgpr_count 2
  .amdhsa_user_sgpr_kernarg_segment_ptr 1
  .amdhsa_system_sgpr_workgroup_id_x 1
.end_amdhsa_kernel
```
